```python
import torch

def _softmax(x, axis=-1):
    return torch.softmax(x, dim=axis)

def _gelu(x):
    return torch.nn.functional.gelu(x, approximate='tanh')

def _silu(x):
    return torch.nn.functional.silu(x)

def _sigmoid(x):
    return torch.sigmoid(x)

def _layernorm(x, axis=-1, eps=1e-05):
    m = x.mean(dim=axis, keepdim=True)
    v = x.var(dim=axis, keepdim=True, unbiased=False)
    return (x - m) / torch.sqrt(v + eps)

def _scatter_add(tgt, idx, src, axis=0):
    return tgt.clone().index_add_(axis, idx, src)

def _segment_sum(src, seg, n):
    out = torch.zeros((n,) + src.shape[1:], dtype=src.dtype)
    return out.index_add_(0, seg, src)

def _pad(x, pw):
    flat = tuple((v for pair in reversed(pw) for v in pair))
    return torch.nn.functional.pad(x, flat)
kernel_name = 'parallel_sum__ssm_conv_s4d__mixer_gmlp__prompt'

def setup_inputs():

    _w = lambda a: (lambda t: t.to(torch.bfloat16) if t.is_floating_point() else t)(torch.as_tensor(a))

    def _A_setup():
        Bsz, L, D, N = (1, 2048, 448, 256)
        return {'u': _w((lambda *s: torch.randn(*s, dtype=torch.bfloat16) * 0.05)(Bsz, L, D)), 'log_A_real': _w((lambda *s: torch.randn(*s, dtype=torch.bfloat16) * 12.8)(D, N) * 0.5), 'A_imag': _w((lambda *s: torch.randn(*s, dtype=torch.bfloat16) * 0.1)(D, N) * 3.14), 'C_real': _w((lambda *s: torch.randn(*s, dtype=torch.bfloat16) * 3.2)(D, N) / N ** 0.5), 'C_imag': _w((lambda *s: torch.randn(*s, dtype=torch.bfloat16) * 3.2)(D, N) / N ** 0.5), 'log_dt': _w((lambda *s: torch.randn(*s, dtype=torch.bfloat16) * 0.1)(D) * 0.5 - 4.0), 'D_skip': _w((lambda *s: torch.randn(*s, dtype=torch.bfloat16) * 0.8)(D))}
    _A_in = _A_setup()

    def _B_setup():
        B, S, D, F = (1, 2048, 448, 1792)
        Fh = F // 2
        return {'x': _w((lambda *s: torch.randn(*s, dtype=torch.bfloat16) * 0.05)(B, S, D)), 'w_in': _w((lambda *s: torch.randn(*s, dtype=torch.bfloat16) * 0.4)(D, 2 * Fh)), 'w_sp': _w(0.01 * (lambda *s: torch.randn(*s, dtype=torch.bfloat16) * 0.4)(S, S)), 'b_sp': _w(1.0 + 0.01 * (lambda *s: torch.randn(*s, dtype=torch.bfloat16) * 0.05)(S)), 'w_out': _w((lambda *s: torch.randn(*s, dtype=torch.bfloat16) * 0.05)(Fh, D))}
    _B_in = _B_setup()
    return {'A_u': _A_in['u'], 'A_log_A_real': _A_in['log_A_real'], 'A_A_imag': _A_in['A_imag'], 'A_C_real': _A_in['C_real'], 'A_C_imag': _A_in['C_imag'], 'A_log_dt': _A_in['log_dt'], 'A_D_skip': _A_in['D_skip'], 'B_x': _B_in['x'], 'B_w_in': _B_in['w_in'], 'B_w_sp': _B_in['w_sp'], 'B_b_sp': _B_in['b_sp'], 'B_w_out': _B_in['w_out']}

def reference(A_u, A_log_A_real, A_A_imag, A_C_real, A_C_imag, A_log_dt, A_D_skip, B_x, B_w_in, B_w_sp, B_b_sp, B_w_out):

    def _A_ref(u, log_A_real, A_imag, C_real, C_imag, log_dt, D_skip):
        L = u.shape[1]
        dt = torch.exp(log_dt)
        A = -torch.exp(log_A_real) + 1j * A_imag
        C = (C_real + 1j * C_imag) * dt[:, None]
        pos = (lambda x, dt: x.to(dt))(torch.arange(L), log_dt.dtype)
        P = torch.exp((A * dt[:, None])[:, :, None] * pos[None, None, :])
        K = 2.0 * torch.einsum('dn,dnl->dl', C, P).real
        L2 = 2 * L
        u_t = (lambda x, *d: x.permute(*d))(u, 0, 2, 1)
        Kf = (lambda x, *a, **k: torch.fft.rfft(x.float(), *a, **k))(K, L2)
        Uf = (lambda x, *a, **k: torch.fft.rfft(x.float(), *a, **k))(u_t, L2)
        y = (lambda x, *a, **k: torch.fft.irfft(x, *a, **k).to(torch.bfloat16))(Uf * Kf[None, :, :], L2)[:, :, :L]
        y = (lambda x, *d: x.permute(*d))(y, 0, 2, 1)
        return y + u * D_skip[None, None, :]

    def _B_ref(x, w_in, w_sp, b_sp, w_out):
        B, S, D = x.shape
        F = w_in.shape[-1]
        Fh = F // 2
        z = _gelu(torch.einsum('bsd,df->bsf', x, w_in))
        z1 = z[..., :Fh].clone()
        z2 = _layernorm(z[..., Fh:], axis=-1)
        g = torch.einsum('ts,bsf->btf', w_sp, z2) + b_sp[None, :, None]
        return torch.einsum('bsf,fd->bsd', z1 * g, w_out)
    x = A_u
    xn = _layernorm(x, axis=-1)
    return x + _A_ref(xn, A_log_A_real, A_A_imag, A_C_real, A_C_imag, A_log_dt, A_D_skip) + _B_ref(xn, B_w_in, B_w_sp, B_b_sp, B_w_out)
```

```asm
; @launch kernel=k1_kernel grid=(256,1,1) block=(512,1,1) lds=163840
; @launch kernel=k2_kernel grid=(512,1,1) block=(256,1,1) lds=81920
.amdgcn_target "amdgcn-amd-amdhsa--gfx950"
.text
.globl k1_kernel
.p2align 8
.type k1_kernel,@function
k1_kernel:
    s_cmp_ge_u32 s2, 256
    s_cbranch_scc1 K1_END
    s_load_dwordx2 s[8:9], s[0:1], 0
    s_load_dwordx2 s[12:13], s[0:1], 64
    s_load_dwordx2 s[16:17], s[0:1], 112
    s_load_dwordx2 s[20:21], s[0:1], 104
    s_load_dwordx2 s[24:25], s[0:1], 88
    s_load_dwordx2 s[4:5], s[0:1], 72
    s_mov_b32 s10, 1835008
    s_mov_b32 s11, 0x00020000
    s_mov_b32 s14, 1605632
    s_mov_b32 s15, 0x00020000
    s_mov_b32 s18, 268435456
    s_mov_b32 s19, 0x00020000
    s_mov_b32 s22, 256
    s_mov_b32 s23, 0x00020000
    s_mov_b32 s26, 802816
    s_mov_b32 s27, 0x00020000
    s_mov_b32 s6, 8388608
    s_mov_b32 s7, 0x00020000
    v_and_b32 v1, 63, v0
    v_lshrrev_b32 v2, 6, v0
    s_nop 0
    v_readfirstlane_b32 s28, v2
    s_cmp_ge_u32 s2, 224
    s_cbranch_scc1 K1_AUX
    s_and_b32 s33, s2, 7
    s_lshr_b32 s34, s2, 3
    s_lshr_b32 s29, s33, 1
    s_lshl_b32 s29, s29, 2
    s_and_b32 s35, s34, 3
    s_add_u32 s29, s29, s35
    s_and_b32 s30, s33, 1
    s_mul_i32 s30, s30, 7
    s_lshr_b32 s35, s34, 2
    s_add_u32 s30, s30, s35
    s_and_b32 s31, s28, 3
    s_lshr_b32 s32, s28, 2
    v_lshrrev_b32 v6, 3, v1
    v_and_b32 v7, 7, v1
    v_lshrrev_b32 v8, 1, v6
    v_xor_b32 v9, v7, v8
    v_xor_b32 v10, 4, v9
    s_lshl_b32 s33, s29, 7
    s_lshl_b32 s34, s28, 4
    s_add_u32 s34, s34, s33
    v_add_u32 v11, s34, v6
    v_mul_u32_u24 v11, 896, v11
    v_lshl_add_u32 v3, v9, 4, v11
    v_lshl_add_u32 v4, v10, 4, v11
    v_add_u32 v4, 7168, v4
    v_and_b32 v9, 1, v8
    v_lshlrev_b32 v9, 2, v9
    v_xor_b32 v9, v7, v9
    s_lshl_b32 s34, s28, 3
    v_add_u32 v11, s34, v6
    v_mul_u32_u24 v11, 3584, v11
    v_lshl_add_u32 v5, v9, 4, v11
    s_lshl_b32 s34, s30, 7
    v_add_u32 v5, s34, v5
    s_lshl_b32 s36, s28, 11
    s_lshl_b32 s37, s28, 10
    s_waitcnt lgkmcnt(0)
    v_mov_b32 v30, 0
    s_lshl_b32 s49, s29, 7
    s_add_u32 s49, s49, 18022400
    buffer_load_dword v31, v30, s[16:19], s49 offen
    s_add_u32 m0, s36, 0
    s_mov_b32 s40, 0
    buffer_load_dwordx4 v3, s[8:11], s40 offen lds
    s_add_u32 m0, s36, 1024
    s_mov_b32 s41, 1792
    buffer_load_dwordx4 v4, s[8:11], s40 offen lds
    s_add_u32 m0, s37, 16384
    s_nop 0
    buffer_load_dwordx4 v5, s[12:15], s41 offen lds
    s_add_u32 m0, s36, 24576
    s_mov_b32 s40, 128
    buffer_load_dwordx4 v3, s[8:11], s40 offen lds
    s_add_u32 m0, s36, 25600
    s_mov_b32 s41, 231168
    buffer_load_dwordx4 v4, s[8:11], s40 offen lds
    s_add_u32 m0, s37, 40960
    s_nop 0
    buffer_load_dwordx4 v5, s[12:15], s41 offen lds
    s_add_u32 m0, s36, 49152
    s_mov_b32 s40, 256
    buffer_load_dwordx4 v3, s[8:11], s40 offen lds
    s_add_u32 m0, s36, 50176
    s_mov_b32 s41, 460544
    buffer_load_dwordx4 v4, s[8:11], s40 offen lds
    s_add_u32 m0, s37, 65536
    s_nop 0
    buffer_load_dwordx4 v5, s[12:15], s41 offen lds
    s_add_u32 m0, s36, 73728
    s_mov_b32 s40, 384
    buffer_load_dwordx4 v3, s[8:11], s40 offen lds
    s_add_u32 m0, s36, 74752
    s_mov_b32 s41, 689920
    buffer_load_dwordx4 v4, s[8:11], s40 offen lds
    s_add_u32 m0, s37, 90112
    s_nop 0
    buffer_load_dwordx4 v5, s[12:15], s41 offen lds
    v_and_b32 v6, 31, v1
    v_lshrrev_b32 v7, 5, v1
    v_bfe_u32 v8, v6, 1, 3
    v_xor_b32 v8, v8, v7
    s_lshl_b32 s34, s31, 5
    v_add_u32 v9, s34, v6
    v_lshlrev_b32 v9, 7, v9
    v_lshl_add_u32 v12, v8, 4, v9
    s_lshl_b32 s45, s32, 1
    s_xor_b32 s45, s45, s31
    s_lshl_b32 s34, s45, 5
    v_xor_b32 v12, s34, v12
    v_xor_b32 v13, 32, v12
    v_xor_b32 v14, 64, v12
    v_xor_b32 v15, 96, v12
    v_add_u32 v16, 73728, v12
    v_add_u32 v17, 73728, v13
    v_add_u32 v18, 73728, v14
    v_add_u32 v19, 73728, v15
    v_bfe_u32 v8, v1, 2, 2
    v_lshl_add_u32 v9, v7, 3, v8
    v_lshlrev_b32 v9, 7, v9
    v_bfe_u32 v10, v1, 4, 1
    v_lshlrev_b32 v10, 1, v10
    v_bfe_u32 v11, v1, 1, 1
    v_add_u32 v10, v10, v11
    s_lshl_b32 s34, s32, 2
    v_add_u32 v10, s34, v10
    v_lshrrev_b32 v8, 1, v8
    v_lshlrev_b32 v8, 2, v8
    v_xor_b32 v10, v10, v8
    v_lshl_add_u32 v9, v10, 4, v9
    v_and_b32 v11, 1, v1
    v_lshl_add_u32 v20, v11, 3, v9
    v_add_u32 v25, 24576, v20
    v_add_u32 v20, 16384, v20
    v_add_u32 v21, 73728, v20
    s_lshl_b32 s43, s31, 1
    s_add_u32 s43, s43, s32
    v_bfe_u32 v8, v1, 2, 2
    v_bfe_u32 v10, v1, 4, 1
    v_lshl_add_u32 v8, v10, 3, v8
    s_and_b32 s34, s30, 1
    s_lshl_b32 s34, s34, 2
    v_lshrrev_b32 v10, 5, v1
    v_lshlrev_b32 v10, 1, v10
    v_bfe_u32 v11, v1, 1, 1
    v_add3_u32 v10, v10, v11, s34
    v_lshrrev_b32 v11, 1, v8
    v_xor_b32 v10, v10, v11
    v_lshlrev_b32 v8, 7, v8
    v_lshl_add_u32 v8, v10, 4, v8
    v_and_b32 v11, 1, v1
    v_lshl_add_u32 v8, v11, 3, v8
    s_lshr_b32 s38, s30, 1
    s_cmp_eq_u32 s38, 6
    s_cselect_b32 s34, 0, s38
    s_mul_i32 s34, s34, 24576
    s_lshl_b32 s35, s43, 11
    s_add_u32 s34, s34, s35
    v_xor_b32 v23, 32, v8
    v_add_u32 v22, s34, v8
    v_add_u32 v23, s34, v23
    v_add_u32 v23, 512, v23
    v_lshlrev_b32 v24, 4, v1
    v_mov_b32 v30, 0
    s_mov_b32 s44, 0x3f803f80
    v_mov_b32 v208, 0
    v_mov_b32 v209, 0
    v_mov_b32 v210, 0
    v_mov_b32 v211, 0
    v_mov_b32 v212, 0
    v_mov_b32 v213, 0
    v_mov_b32 v214, 0
    v_mov_b32 v215, 0
    v_mov_b32 v216, 0
    v_mov_b32 v217, 0
    v_mov_b32 v218, 0
    v_mov_b32 v219, 0
    v_mov_b32 v220, 0
    v_mov_b32 v221, 0
    v_mov_b32 v222, 0
    v_mov_b32 v223, 0
    v_lshrrev_b32 v6, 2, v1
    v_lshrrev_b32 v7, 4, v1
    v_xor_b32 v6, v6, v7
    v_and_b32 v6, 1, v6
    v_add_u32 v6, -1, v6
    v_and_b32 v232, s44, v6
    v_and_b32 v233, s44, v6
    v_and_b32 v234, s44, v6
    v_and_b32 v235, s44, v6
    v_mov_b32 v242, 0xc0135761
    v_mov_b32 v243, 0xbdd2d3e8
    v_mov_b32 v244, 1.0
    v_mov_b32 v245, 1.0
    s_lshl_b32 s34, s28, 9
    s_add_u32 s34, s34, 155648
    v_and_b32 v6, 31, v1
    v_lshl_add_u32 v246, v6, 3, s34
    v_bfe_u32 v7, v1, 4, 1
    s_lshl_b32 s35, s32, 7
    s_add_u32 s34, s34, s35
    v_lshl_add_u32 v249, v7, 6, s34
    s_lshl_b32 s34, s31, 8
    s_add_u32 s34, s34, 98304
    v_lshl_add_u32 v250, v6, 3, s34
    s_lshl_b32 s34, s32, 9
    s_add_u32 s34, s34, 159744
    v_and_b32 v6, 31, v1
    v_lshl_add_u32 v255, v6, 4, s34
    s_lshl_b32 s35, s31, 2
    v_add_u32 v254, s35, v255
    s_lshl_b32 s34, s31, 9
    s_add_u32 s34, s34, 161792
    v_lshl_add_u32 v247, v6, 4, s34
    s_lshl_b32 s35, s32, 3
    v_add_u32 v251, s35, v247
    s_lshl_b32 s34, s28, 9
    s_add_u32 s34, s34, 155904
    v_lshl_add_u32 v252, v6, 2, s34
    v_lshrrev_b32 v7, 5, v1
    v_lshl_add_u32 v253, v7, 4, s34
    s_xor_b32 s34, s45, 0
    s_lshl_b32 s34, s34, 11
    v_add_u32 v6, s34, v20
    v_add_u32 v236, s34, v21
    s_xor_b32 s34, s45, 1
    s_lshl_b32 s34, s34, 11
    v_add_u32 v7, s34, v20
    v_add_u32 v237, s34, v21
    s_xor_b32 s34, s45, 2
    s_lshl_b32 s34, s34, 11
    v_add_u32 v8, s34, v20
    v_add_u32 v238, s34, v21
    s_xor_b32 s34, s45, 3
    s_lshl_b32 s34, s34, 11
    v_add_u32 v9, s34, v20
    v_add_u32 v239, s34, v21
    s_waitcnt vmcnt(9)
    s_waitcnt lgkmcnt(0)
    s_barrier
    s_cmp_lg_u32 s38, 0
    s_cbranch_scc1 K1_NOGRAB0
    ds_read_b64_tr_b16 v[26:27], v22
    ds_read_b64_tr_b16 v[28:29], v23
K1_NOGRAB0:
    ds_read_b128 v[64:67], v12 offset:0
    ds_read_b64_tr_b16 v[176:177], v6 offset:0
    ds_read_b64_tr_b16 v[178:179], v6 offset:512
    ds_read_b128 v[68:71], v13 offset:0
    ds_read_b64_tr_b16 v[180:181], v7 offset:0
    ds_read_b64_tr_b16 v[182:183], v7 offset:512
    ds_read_b128 v[72:75], v14 offset:0
    ds_read_b64_tr_b16 v[184:185], v8 offset:0
    ds_read_b64_tr_b16 v[186:187], v8 offset:512
    ds_read_b128 v[76:79], v15 offset:0
    ds_read_b64_tr_b16 v[188:189], v9 offset:0
    ds_read_b64_tr_b16 v[190:191], v9 offset:512
    s_add_u32 m0, s36, 98304
    s_mov_b32 s40, 512
    buffer_load_dwordx4 v3, s[8:11], s40 offen lds
    s_add_u32 m0, s36, 99328
    s_mov_b32 s41, 919296
    buffer_load_dwordx4 v4, s[8:11], s40 offen lds
    s_add_u32 m0, s37, 114688
    s_nop 0
    buffer_load_dwordx4 v5, s[12:15], s41 offen lds
    s_add_u32 m0, s36, 122880
    s_mov_b32 s40, 640
    buffer_load_dwordx4 v3, s[8:11], s40 offen lds
    s_add_u32 m0, s36, 123904
    s_mov_b32 s41, 1148672
    buffer_load_dwordx4 v4, s[8:11], s40 offen lds
    s_add_u32 m0, s37, 139264
    s_nop 0
    buffer_load_dwordx4 v5, s[12:15], s41 offen lds
    s_waitcnt vmcnt(12)
    s_waitcnt lgkmcnt(0)
    s_barrier
    s_cmp_lg_u32 s38, 1
    s_cbranch_scc1 K1_NOGRAB1
    ds_read_b64_tr_b16 v[26:27], v22
    ds_read_b64_tr_b16 v[28:29], v23
K1_NOGRAB1:
    ds_read_b128 v[80:83], v12 offset:24576
    ds_read_b64_tr_b16 v[192:193], v6 offset:24576
    ds_read_b64_tr_b16 v[194:195], v6 offset:25088
    ds_read_b128 v[84:87], v13 offset:24576
    ds_read_b64_tr_b16 v[196:197], v7 offset:24576
    ds_read_b64_tr_b16 v[198:199], v7 offset:25088
    ds_read_b128 v[88:91], v14 offset:24576
    ds_read_b64_tr_b16 v[200:201], v8 offset:24576
    ds_read_b64_tr_b16 v[202:203], v8 offset:25088
    ds_read_b128 v[92:95], v15 offset:24576
    ds_read_b64_tr_b16 v[204:205], v9 offset:24576
    ds_read_b64_tr_b16 v[206:207], v9 offset:25088
    v_mfma_f32_32x32x16_bf16 v[32:47], v[176:179], v[64:67], 0
    v_lshlrev_b32 v224, 16, v64
    v_and_b32 v225, 0xffff0000, v64
    v_lshlrev_b32 v226, 16, v65
    v_and_b32 v227, 0xffff0000, v65
    v_mfma_f32_16x16x32_bf16 v[208:211], v[232:235], v[64:67], v[208:211]
    v_fmac_f32 v212, v224, v224
    v_fmac_f32 v213, v225, v225
    v_fmac_f32 v214, v226, v226
    v_fmac_f32 v215, v227, v227
    s_add_u32 m0, s36, 0
    s_mov_b32 s40, 768
    buffer_load_dwordx4 v3, s[8:11], s40 offen lds
    v_mfma_f32_32x32x16_bf16 v[32:47], v[180:183], v[68:71], v[32:47]
    v_lshlrev_b32 v224, 16, v66
    v_and_b32 v225, 0xffff0000, v66
    v_lshlrev_b32 v226, 16, v67
    v_and_b32 v227, 0xffff0000, v67
    v_mfma_f32_16x16x32_bf16 v[208:211], v[232:235], v[68:71], v[208:211]
    v_fmac_f32 v212, v224, v224
    v_fmac_f32 v213, v225, v225
    v_fmac_f32 v214, v226, v226
    v_fmac_f32 v215, v227, v227
    s_add_u32 m0, s36, 1024
    s_mov_b32 s41, 1378048
    buffer_load_dwordx4 v4, s[8:11], s40 offen lds
    v_mfma_f32_32x32x16_bf16 v[32:47], v[184:187], v[72:75], v[32:47]
    v_lshlrev_b32 v224, 16, v68
    v_and_b32 v225, 0xffff0000, v68
    v_lshlrev_b32 v226, 16, v69
    v_and_b32 v227, 0xffff0000, v69
    v_mfma_f32_16x16x32_bf16 v[216:219], v[232:235], v[176:179], v[216:219]
    v_fmac_f32 v212, v224, v224
    v_fmac_f32 v213, v225, v225
    v_fmac_f32 v214, v226, v226
    v_fmac_f32 v215, v227, v227
    s_add_u32 m0, s37, 16384
    s_nop 0
    buffer_load_dwordx4 v5, s[12:15], s41 offen lds
    v_mfma_f32_32x32x16_bf16 v[32:47], v[188:191], v[76:79], v[32:47]
    v_lshlrev_b32 v224, 16, v70
    v_and_b32 v225, 0xffff0000, v70
    v_lshlrev_b32 v226, 16, v71
    v_and_b32 v227, 0xffff0000, v71
    v_fmac_f32 v212, v224, v224
    v_fmac_f32 v213, v225, v225
    v_fmac_f32 v214, v226, v226
    v_fmac_f32 v215, v227, v227
    s_waitcnt vmcnt(12)
    s_waitcnt lgkmcnt(0)
    s_barrier
    s_cmp_lg_u32 s38, 2
    s_cbranch_scc1 K1_NOGRAB2
    ds_read_b64_tr_b16 v[26:27], v22
    ds_read_b64_tr_b16 v[28:29], v23
K1_NOGRAB2:
    ds_read_b128 v[96:99], v12 offset:49152
    ds_read_b64_tr_b16 v[176:177], v6 offset:49152
    ds_read_b64_tr_b16 v[178:179], v6 offset:49664
    ds_read_b128 v[100:103], v13 offset:49152
    ds_read_b64_tr_b16 v[180:181], v7 offset:49152
    ds_read_b64_tr_b16 v[182:183], v7 offset:49664
    ds_read_b128 v[104:107], v14 offset:49152
    ds_read_b64_tr_b16 v[184:185], v8 offset:49152
    ds_read_b64_tr_b16 v[186:187], v8 offset:49664
    ds_read_b128 v[108:111], v15 offset:49152
    ds_read_b64_tr_b16 v[188:189], v9 offset:49152
    ds_read_b64_tr_b16 v[190:191], v9 offset:49664
    v_mfma_f32_32x32x16_bf16 v[32:47], v[192:195], v[80:83], v[32:47]
    v_lshlrev_b32 v224, 16, v80
    v_and_b32 v225, 0xffff0000, v80
    v_lshlrev_b32 v226, 16, v81
    v_and_b32 v227, 0xffff0000, v81
    v_mfma_f32_16x16x32_bf16 v[208:211], v[232:235], v[80:83], v[208:211]
    v_fmac_f32 v212, v224, v224
    v_fmac_f32 v213, v225, v225
    v_fmac_f32 v214, v226, v226
    v_fmac_f32 v215, v227, v227
    s_add_u32 m0, s37, 24576
    s_mov_b32 s42, 0
    buffer_load_dwordx4 v5, s[12:15], s42 offen lds
    v_mfma_f32_32x32x16_bf16 v[32:47], v[196:199], v[84:87], v[32:47]
    v_lshlrev_b32 v224, 16, v82
    v_and_b32 v225, 0xffff0000, v82
    v_lshlrev_b32 v226, 16, v83
    v_and_b32 v227, 0xffff0000, v83
    v_mfma_f32_16x16x32_bf16 v[208:211], v[232:235], v[84:87], v[208:211]
    v_fmac_f32 v212, v224, v224
    v_fmac_f32 v213, v225, v225
    v_fmac_f32 v214, v226, v226
    v_fmac_f32 v215, v227, v227
    s_add_u32 m0, s37, 32768
    s_mov_b32 s42, 229376
    buffer_load_dwordx4 v5, s[12:15], s42 offen lds
    v_mfma_f32_32x32x16_bf16 v[32:47], v[200:203], v[88:91], v[32:47]
    v_lshlrev_b32 v224, 16, v84
    v_and_b32 v225, 0xffff0000, v84
    v_lshlrev_b32 v226, 16, v85
    v_and_b32 v227, 0xffff0000, v85
    v_mfma_f32_16x16x32_bf16 v[216:219], v[232:235], v[192:195], v[216:219]
    v_fmac_f32 v212, v224, v224
    v_fmac_f32 v213, v225, v225
    v_fmac_f32 v214, v226, v226
    v_fmac_f32 v215, v227, v227
    s_add_u32 m0, s37, 40960
    s_mov_b32 s42, 458752
    buffer_load_dwordx4 v5, s[12:15], s42 offen lds
    v_mfma_f32_32x32x16_bf16 v[32:47], v[204:207], v[92:95], v[32:47]
    v_lshlrev_b32 v224, 16, v86
    v_and_b32 v225, 0xffff0000, v86
    v_lshlrev_b32 v226, 16, v87
    v_and_b32 v227, 0xffff0000, v87
    v_fmac_f32 v212, v224, v224
    v_fmac_f32 v213, v225, v225
    v_fmac_f32 v214, v226, v226
    v_fmac_f32 v215, v227, v227
    s_waitcnt vmcnt(12)
    s_waitcnt lgkmcnt(0)
    s_barrier
    s_cmp_lg_u32 s38, 3
    s_cbranch_scc1 K1_NOGRAB3
    ds_read_b64_tr_b16 v[26:27], v22
    ds_read_b64_tr_b16 v[28:29], v23
K1_NOGRAB3:
    ds_read_b128 v[112:115], v16 offset:0
    ds_read_b64_tr_b16 v[192:193], v236 offset:0
    ds_read_b64_tr_b16 v[194:195], v236 offset:512
    ds_read_b128 v[116:119], v17 offset:0
    ds_read_b64_tr_b16 v[196:197], v237 offset:0
    ds_read_b64_tr_b16 v[198:199], v237 offset:512
    ds_read_b128 v[120:123], v18 offset:0
    ds_read_b64_tr_b16 v[200:201], v238 offset:0
    ds_read_b64_tr_b16 v[202:203], v238 offset:512
    ds_read_b128 v[124:127], v19 offset:0
    ds_read_b64_tr_b16 v[204:205], v239 offset:0
    ds_read_b64_tr_b16 v[206:207], v239 offset:512
    v_mfma_f32_32x32x16_bf16 v[32:47], v[176:179], v[96:99], v[32:47]
    v_lshlrev_b32 v224, 16, v96
    v_and_b32 v225, 0xffff0000, v96
    v_lshlrev_b32 v226, 16, v97
    v_and_b32 v227, 0xffff0000, v97
    v_mfma_f32_16x16x32_bf16 v[208:211], v[232:235], v[96:99], v[208:211]
    v_fmac_f32 v212, v224, v224
    v_fmac_f32 v213, v225, v225
    v_fmac_f32 v214, v226, v226
    v_fmac_f32 v215, v227, v227
    s_add_u32 m0, s37, 49152
    s_mov_b32 s42, 688128
    buffer_load_dwordx4 v5, s[12:15], s42 offen lds
    v_mfma_f32_32x32x16_bf16 v[32:47], v[180:183], v[100:103], v[32:47]
    v_lshlrev_b32 v224, 16, v98
    v_and_b32 v225, 0xffff0000, v98
    v_lshlrev_b32 v226, 16, v99
    v_and_b32 v227, 0xffff0000, v99
    v_mfma_f32_16x16x32_bf16 v[208:211], v[232:235], v[100:103], v[208:211]
    v_fmac_f32 v212, v224, v224
    v_fmac_f32 v213, v225, v225
    v_fmac_f32 v214, v226, v226
    v_fmac_f32 v215, v227, v227
    s_add_u32 m0, s37, 57344
    s_mov_b32 s42, 917504
    buffer_load_dwordx4 v5, s[12:15], s42 offen lds
    v_mfma_f32_32x32x16_bf16 v[32:47], v[184:187], v[104:107], v[32:47]
    v_lshlrev_b32 v224, 16, v100
    v_and_b32 v225, 0xffff0000, v100
    v_lshlrev_b32 v226, 16, v101
    v_and_b32 v227, 0xffff0000, v101
    v_mfma_f32_16x16x32_bf16 v[216:219], v[232:235], v[176:179], v[216:219]
    v_fmac_f32 v212, v224, v224
    v_fmac_f32 v213, v225, v225
    v_fmac_f32 v214, v226, v226
    v_fmac_f32 v215, v227, v227
    s_add_u32 m0, s37, 65536
    s_mov_b32 s42, 1146880
    buffer_load_dwordx4 v5, s[12:15], s42 offen lds
    v_mfma_f32_32x32x16_bf16 v[32:47], v[188:191], v[108:111], v[32:47]
    v_lshlrev_b32 v224, 16, v102
    v_and_b32 v225, 0xffff0000, v102
    v_lshlrev_b32 v226, 16, v103
    v_and_b32 v227, 0xffff0000, v103
    v_fmac_f32 v212, v224, v224
    v_fmac_f32 v213, v225, v225
    v_fmac_f32 v214, v226, v226
    v_fmac_f32 v215, v227, v227
    s_waitcnt vmcnt(12)
    s_waitcnt lgkmcnt(0)
    s_barrier
    s_cmp_lg_u32 s38, 4
    s_cbranch_scc1 K1_NOGRAB4
    ds_read_b64_tr_b16 v[26:27], v22
    ds_read_b64_tr_b16 v[28:29], v23
K1_NOGRAB4:
    ds_read_b128 v[128:131], v16 offset:24576
    ds_read_b64_tr_b16 v[176:177], v236 offset:24576
    ds_read_b64_tr_b16 v[178:179], v236 offset:25088
    ds_read_b128 v[132:135], v17 offset:24576
    ds_read_b64_tr_b16 v[180:181], v237 offset:24576
    ds_read_b64_tr_b16 v[182:183], v237 offset:25088
    ds_read_b128 v[136:139], v18 offset:24576
    ds_read_b64_tr_b16 v[184:185], v238 offset:24576
    ds_read_b64_tr_b16 v[186:187], v238 offset:25088
    ds_read_b128 v[140:143], v19 offset:24576
    ds_read_b64_tr_b16 v[188:189], v239 offset:24576
    ds_read_b64_tr_b16 v[190:191], v239 offset:25088
    v_mfma_f32_32x32x16_bf16 v[32:47], v[192:195], v[112:115], v[32:47]
    v_lshlrev_b32 v224, 16, v112
    v_and_b32 v225, 0xffff0000, v112
    v_lshlrev_b32 v226, 16, v113
    v_and_b32 v227, 0xffff0000, v113
    v_mfma_f32_16x16x32_bf16 v[208:211], v[232:235], v[112:115], v[208:211]
    v_fmac_f32 v212, v224, v224
    v_fmac_f32 v213, v225, v225
    v_fmac_f32 v214, v226, v226
    v_fmac_f32 v215, v227, v227
    s_add_u32 m0, s37, 73728
    s_mov_b32 s42, 1376256
    buffer_load_dwordx4 v5, s[12:15], s42 offen lds
    v_mfma_f32_32x32x16_bf16 v[32:47], v[196:199], v[116:119], v[32:47]
    v_lshlrev_b32 v224, 16, v114
    v_and_b32 v225, 0xffff0000, v114
    v_lshlrev_b32 v226, 16, v115
    v_and_b32 v227, 0xffff0000, v115
    v_mfma_f32_16x16x32_bf16 v[208:211], v[232:235], v[116:119], v[208:211]
    v_fmac_f32 v212, v224, v224
    v_fmac_f32 v213, v225, v225
    v_fmac_f32 v214, v226, v226
    v_fmac_f32 v215, v227, v227
    v_mfma_f32_32x32x16_bf16 v[32:47], v[200:203], v[120:123], v[32:47]
    v_lshlrev_b32 v224, 16, v116
    v_and_b32 v225, 0xffff0000, v116
    v_lshlrev_b32 v226, 16, v117
    v_and_b32 v227, 0xffff0000, v117
    v_mfma_f32_16x16x32_bf16 v[216:219], v[232:235], v[192:195], v[216:219]
    v_fmac_f32 v212, v224, v224
    v_fmac_f32 v213, v225, v225
    v_fmac_f32 v214, v226, v226
    v_fmac_f32 v215, v227, v227
    v_mfma_f32_32x32x16_bf16 v[32:47], v[204:207], v[124:127], v[32:47]
    v_lshlrev_b32 v224, 16, v118
    v_and_b32 v225, 0xffff0000, v118
    v_lshlrev_b32 v226, 16, v119
    v_and_b32 v227, 0xffff0000, v119
    v_fmac_f32 v212, v224, v224
    v_fmac_f32 v213, v225, v225
    v_fmac_f32 v214, v226, v226
    v_fmac_f32 v215, v227, v227
    s_waitcnt vmcnt(10)
    s_waitcnt lgkmcnt(0)
    s_barrier
    s_cmp_lg_u32 s38, 5
    s_cbranch_scc1 K1_NOGRAB5
    ds_read_b64_tr_b16 v[26:27], v22
    ds_read_b64_tr_b16 v[28:29], v23
K1_NOGRAB5:
    ds_read_b128 v[144:147], v16 offset:49152
    ds_read_b64_tr_b16 v[192:193], v236 offset:49152
    ds_read_b64_tr_b16 v[194:195], v236 offset:49664
    ds_read_b128 v[148:151], v17 offset:49152
    ds_read_b64_tr_b16 v[196:197], v237 offset:49152
    ds_read_b64_tr_b16 v[198:199], v237 offset:49664
    ds_read_b128 v[152:155], v18 offset:49152
    ds_read_b64_tr_b16 v[200:201], v238 offset:49152
    ds_read_b64_tr_b16 v[202:203], v238 offset:49664
    ds_read_b128 v[156:159], v19 offset:49152
    ds_read_b64_tr_b16 v[204:205], v239 offset:49152
    ds_read_b64_tr_b16 v[206:207], v239 offset:49664
    v_mfma_f32_32x32x16_bf16 v[32:47], v[176:179], v[128:131], v[32:47]
    v_lshlrev_b32 v224, 16, v128
    v_and_b32 v225, 0xffff0000, v128
    v_lshlrev_b32 v226, 16, v129
    v_and_b32 v227, 0xffff0000, v129
    v_mfma_f32_16x16x32_bf16 v[208:211], v[232:235], v[128:131], v[208:211]
    v_fmac_f32 v212, v224, v224
    v_fmac_f32 v213, v225, v225
    v_fmac_f32 v214, v226, v226
    v_fmac_f32 v215, v227, v227
    v_mfma_f32_32x32x16_bf16 v[32:47], v[180:183], v[132:135], v[32:47]
    v_lshlrev_b32 v224, 16, v130
    v_and_b32 v225, 0xffff0000, v130
    v_lshlrev_b32 v226, 16, v131
    v_and_b32 v227, 0xffff0000, v131
    v_mfma_f32_16x16x32_bf16 v[208:211], v[232:235], v[132:135], v[208:211]
    v_fmac_f32 v212, v224, v224
    v_fmac_f32 v213, v225, v225
    v_fmac_f32 v214, v226, v226
    v_fmac_f32 v215, v227, v227
    v_mfma_f32_32x32x16_bf16 v[32:47], v[184:187], v[136:139], v[32:47]
    v_lshlrev_b32 v224, 16, v132
    v_and_b32 v225, 0xffff0000, v132
    v_lshlrev_b32 v226, 16, v133
    v_and_b32 v227, 0xffff0000, v133
    v_mfma_f32_16x16x32_bf16 v[216:219], v[232:235], v[176:179], v[216:219]
    v_fmac_f32 v212, v224, v224
    v_fmac_f32 v213, v225, v225
    v_fmac_f32 v214, v226, v226
    v_fmac_f32 v215, v227, v227
    v_mfma_f32_32x32x16_bf16 v[32:47], v[188:191], v[140:143], v[32:47]
    v_lshlrev_b32 v224, 16, v134
    v_and_b32 v225, 0xffff0000, v134
    v_lshlrev_b32 v226, 16, v135
    v_and_b32 v227, 0xffff0000, v135
    v_fmac_f32 v212, v224, v224
    v_fmac_f32 v213, v225, v225
    v_fmac_f32 v214, v226, v226
    v_fmac_f32 v215, v227, v227
    s_lshl_b32 s34, s2, 3
    s_add_u32 s34, s34, s28
    s_mul_i32 s34, s34, 4736
    v_min_u32 v4, 36, v1
    v_lshlrev_b32 v4, 7, v4
    buffer_load_dword v4, v4, s[4:7], s34 offen
    s_waitcnt vmcnt(8)
    s_waitcnt lgkmcnt(0)
    s_barrier
    s_cmp_lg_u32 s38, 6
    s_cbranch_scc1 K1_NOGRAB6
    ds_read_b64_tr_b16 v[26:27], v22
    ds_read_b64_tr_b16 v[28:29], v23
K1_NOGRAB6:
    ds_read_b128 v[160:163], v12 offset:0
    ds_read_b64_tr_b16 v[176:177], v6 offset:0
    ds_read_b64_tr_b16 v[178:179], v6 offset:512
    ds_read_b128 v[164:167], v13 offset:0
    ds_read_b64_tr_b16 v[180:181], v7 offset:0
    ds_read_b64_tr_b16 v[182:183], v7 offset:512
    ds_read_b128 v[168:171], v14 offset:0
    ds_read_b64_tr_b16 v[184:185], v8 offset:0
    ds_read_b64_tr_b16 v[186:187], v8 offset:512
    ds_read_b128 v[172:175], v15 offset:0
    ds_read_b64_tr_b16 v[188:189], v9 offset:0
    ds_read_b64_tr_b16 v[190:191], v9 offset:512
    v_mfma_f32_32x32x16_bf16 v[32:47], v[192:195], v[144:147], v[32:47]
    v_lshlrev_b32 v224, 16, v144
    v_and_b32 v225, 0xffff0000, v144
    v_lshlrev_b32 v226, 16, v145
    v_and_b32 v227, 0xffff0000, v145
    v_mfma_f32_16x16x32_bf16 v[208:211], v[232:235], v[144:147], v[208:211]
    v_fmac_f32 v212, v224, v224
    v_fmac_f32 v213, v225, v225
    v_fmac_f32 v214, v226, v226
    v_fmac_f32 v215, v227, v227
    v_mfma_f32_32x32x16_bf16 v[32:47], v[196:199], v[148:151], v[32:47]
    v_lshlrev_b32 v224, 16, v146
    v_and_b32 v225, 0xffff0000, v146
    v_lshlrev_b32 v226, 16, v147
    v_and_b32 v227, 0xffff0000, v147
    v_mfma_f32_16x16x32_bf16 v[208:211], v[232:235], v[148:151], v[208:211]
    v_fmac_f32 v212, v224, v224
    v_fmac_f32 v213, v225, v225
    v_fmac_f32 v214, v226, v226
    v_fmac_f32 v215, v227, v227
    v_mfma_f32_32x32x16_bf16 v[32:47], v[200:203], v[152:155], v[32:47]
    v_lshlrev_b32 v224, 16, v148
    v_and_b32 v225, 0xffff0000, v148
    v_lshlrev_b32 v226, 16, v149
    v_and_b32 v227, 0xffff0000, v149
    v_mfma_f32_16x16x32_bf16 v[216:219], v[232:235], v[192:195], v[216:219]
    v_fmac_f32 v212, v224, v224
    v_fmac_f32 v213, v225, v225
    v_fmac_f32 v214, v226, v226
    v_fmac_f32 v215, v227, v227
    v_mfma_f32_32x32x16_bf16 v[32:47], v[204:207], v[156:159], v[32:47]
    v_lshlrev_b32 v224, 16, v150
    v_and_b32 v225, 0xffff0000, v150
    v_lshlrev_b32 v226, 16, v151
    v_and_b32 v227, 0xffff0000, v151
    v_fmac_f32 v212, v224, v224
    v_fmac_f32 v213, v225, v225
    v_fmac_f32 v214, v226, v226
    v_fmac_f32 v215, v227, v227
    s_waitcnt lgkmcnt(0)
    v_mfma_f32_32x32x16_bf16 v[32:47], v[176:179], v[160:163], v[32:47]
    v_lshlrev_b32 v224, 16, v160
    v_and_b32 v225, 0xffff0000, v160
    v_lshlrev_b32 v226, 16, v161
    v_and_b32 v227, 0xffff0000, v161
    v_mfma_f32_16x16x32_bf16 v[208:211], v[232:235], v[160:163], v[208:211]
    v_fmac_f32 v212, v224, v224
    v_fmac_f32 v213, v225, v225
    v_fmac_f32 v214, v226, v226
    v_fmac_f32 v215, v227, v227
    v_mfma_f32_32x32x16_bf16 v[32:47], v[180:183], v[164:167], v[32:47]
    v_lshlrev_b32 v224, 16, v162
    v_and_b32 v225, 0xffff0000, v162
    v_lshlrev_b32 v226, 16, v163
    v_and_b32 v227, 0xffff0000, v163
    v_mfma_f32_16x16x32_bf16 v[208:211], v[232:235], v[164:167], v[208:211]
    v_fmac_f32 v212, v224, v224
    v_fmac_f32 v213, v225, v225
    v_fmac_f32 v214, v226, v226
    v_fmac_f32 v215, v227, v227
    v_mfma_f32_32x32x16_bf16 v[32:47], v[184:187], v[168:171], v[32:47]
    v_lshlrev_b32 v224, 16, v164
    v_and_b32 v225, 0xffff0000, v164
    v_lshlrev_b32 v226, 16, v165
    v_and_b32 v227, 0xffff0000, v165
    v_mfma_f32_16x16x32_bf16 v[216:219], v[232:235], v[176:179], v[216:219]
    v_fmac_f32 v212, v224, v224
    v_fmac_f32 v213, v225, v225
    v_fmac_f32 v214, v226, v226
    v_fmac_f32 v215, v227, v227
    v_mfma_f32_32x32x16_bf16 v[32:47], v[188:191], v[172:175], v[32:47]
    v_lshlrev_b32 v224, 16, v166
    v_and_b32 v225, 0xffff0000, v166
    v_lshlrev_b32 v226, 16, v167
    v_and_b32 v227, 0xffff0000, v167
    v_fmac_f32 v212, v224, v224
    v_fmac_f32 v213, v225, v225
    v_fmac_f32 v214, v226, v226
    v_fmac_f32 v215, v227, v227
    v_add_f32 v212, v212, v213
    v_add_f32 v214, v214, v215
    v_add_f32 v212, v212, v214
    v_mov_b32 v213, v212
    s_nop 1
    v_permlane32_swap_b32 v212, v213
    v_add_f32 v212, v212, v213
    v_mov_b32 v209, v212
    ds_write_b64 v251, v[208:209]
    ds_write_b32 v254, v216 offset:1024
    v_add_u32 v6, 8192, v6
    v_add_u32 v7, 8192, v7
    v_add_u32 v8, 8192, v8
    v_add_u32 v9, 8192, v9
    s_waitcnt lgkmcnt(0)
    s_barrier
    ds_read_b128 v[224:227], v255 offset:1024
    ds_read_b128 v[228:231], v247
    s_waitcnt lgkmcnt(1)
    v_add_f32 v224, v224, v225
    v_add_f32 v226, v226, v227
    v_add_f32 v224, v224, v226
    ds_write_b32 v252, v224
    ds_read_b128 v[176:179], v253 offset:0
    ds_read_b128 v[180:183], v253 offset:32
    ds_read_b128 v[184:187], v253 offset:64
    ds_read_b128 v[188:191], v253 offset:96
    s_waitcnt lgkmcnt(5)
    v_add_f32 v240, v228, v230
    v_add_f32 v241, v229, v231
    v_mul_f32 v240, 0x3b124925, v240
    v_mul_f32 v241, 0x3b124925, v241
    v_fma_f32 v241, -v240, v240, v241
    v_max_f32 v241, 0, v241
    v_cvt_pk_bf16_f32 v240, v240, v240
    v_lshlrev_b32 v240, 16, v240
    v_cvt_pk_bf16_f32 v241, v241, v241
    v_lshlrev_b32 v241, 16, v241
    v_add_f32 v241, 0x3727c5ac, v241
    v_cvt_pk_bf16_f32 v241, v241, v241
    v_lshlrev_b32 v241, 16, v241
    v_sqrt_f32 v241, v241
    s_nop 0
    v_cvt_pk_bf16_f32 v241, v241, v241
    v_lshlrev_b32 v241, 16, v241
    v_rcp_f32 v241, v241
    ds_write_b64 v246, v[240:241]
    s_waitcnt lgkmcnt(1)
    v_pk_fma_f32 v[32:33], v[176:177], v[240:241], v[32:33] op_sel:[0,0,0] op_sel_hi:[1,0,1] neg_lo:[1,0,0] neg_hi:[1,0,0]
    v_pk_fma_f32 v[34:35], v[178:179], v[240:241], v[34:35] op_sel:[0,0,0] op_sel_hi:[1,0,1] neg_lo:[1,0,0] neg_hi:[1,0,0]
    v_pk_fma_f32 v[36:37], v[180:181], v[240:241], v[36:37] op_sel:[0,0,0] op_sel_hi:[1,0,1] neg_lo:[1,0,0] neg_hi:[1,0,0]
    v_pk_fma_f32 v[38:39], v[182:183], v[240:241], v[38:39] op_sel:[0,0,0] op_sel_hi:[1,0,1] neg_lo:[1,0,0] neg_hi:[1,0,0]
    v_pk_fma_f32 v[40:41], v[184:185], v[240:241], v[40:41] op_sel:[0,0,0] op_sel_hi:[1,0,1] neg_lo:[1,0,0] neg_hi:[1,0,0]
    v_pk_fma_f32 v[42:43], v[186:187], v[240:241], v[42:43] op_sel:[0,0,0] op_sel_hi:[1,0,1] neg_lo:[1,0,0] neg_hi:[1,0,0]
    v_pk_fma_f32 v[44:45], v[188:189], v[240:241], v[44:45] op_sel:[0,0,0] op_sel_hi:[1,0,1] neg_lo:[1,0,0] neg_hi:[1,0,0]
    v_pk_fma_f32 v[46:47], v[190:191], v[240:241], v[46:47] op_sel:[0,0,0] op_sel_hi:[1,0,1] neg_lo:[1,0,0] neg_hi:[1,0,0]
    v_pk_mul_f32 v[32:33], v[32:33], v[240:241] op_sel:[0,1] op_sel_hi:[1,1]
    v_pk_mul_f32 v[34:35], v[34:35], v[240:241] op_sel:[0,1] op_sel_hi:[1,1]
    v_pk_mul_f32 v[36:37], v[36:37], v[240:241] op_sel:[0,1] op_sel_hi:[1,1]
    v_pk_mul_f32 v[38:39], v[38:39], v[240:241] op_sel:[0,1] op_sel_hi:[1,1]
    v_pk_mul_f32 v[40:41], v[40:41], v[240:241] op_sel:[0,1] op_sel_hi:[1,1]
    v_pk_mul_f32 v[42:43], v[42:43], v[240:241] op_sel:[0,1] op_sel_hi:[1,1]
    v_pk_mul_f32 v[44:45], v[44:45], v[240:241] op_sel:[0,1] op_sel_hi:[1,1]
    v_pk_mul_f32 v[46:47], v[46:47], v[240:241] op_sel:[0,1] op_sel_hi:[1,1]
    v_pk_mul_f32 v[192:193], v[32:33], v[32:33]
    v_pk_mul_f32 v[194:195], v[34:35], v[34:35]
    v_pk_mul_f32 v[196:197], v[36:37], v[36:37]
    v_pk_mul_f32 v[198:199], v[38:39], v[38:39]
    v_pk_mul_f32 v[200:201], v[40:41], v[40:41]
    v_pk_mul_f32 v[202:203], v[42:43], v[42:43]
    v_pk_mul_f32 v[204:205], v[44:45], v[44:45]
    v_pk_mul_f32 v[206:207], v[46:47], v[46:47]
    v_pk_fma_f32 v[192:193], v[192:193], v[242:243], v[242:243] op_sel:[0,1,0] op_sel_hi:[1,1,0]
    v_pk_fma_f32 v[194:195], v[194:195], v[242:243], v[242:243] op_sel:[0,1,0] op_sel_hi:[1,1,0]
    v_pk_fma_f32 v[196:197], v[196:197], v[242:243], v[242:243] op_sel:[0,1,0] op_sel_hi:[1,1,0]
    v_pk_fma_f32 v[198:199], v[198:199], v[242:243], v[242:243] op_sel:[0,1,0] op_sel_hi:[1,1,0]
    v_pk_fma_f32 v[200:201], v[200:201], v[242:243], v[242:243] op_sel:[0,1,0] op_sel_hi:[1,1,0]
    v_pk_fma_f32 v[202:203], v[202:203], v[242:243], v[242:243] op_sel:[0,1,0] op_sel_hi:[1,1,0]
    v_pk_fma_f32 v[204:205], v[204:205], v[242:243], v[242:243] op_sel:[0,1,0] op_sel_hi:[1,1,0]
    v_pk_fma_f32 v[206:207], v[206:207], v[242:243], v[242:243] op_sel:[0,1,0] op_sel_hi:[1,1,0]
    v_pk_mul_f32 v[192:193], v[192:193], v[32:33]
    v_pk_mul_f32 v[194:195], v[194:195], v[34:35]
    v_pk_mul_f32 v[196:197], v[196:197], v[36:37]
    v_pk_mul_f32 v[198:199], v[198:199], v[38:39]
    v_pk_mul_f32 v[200:201], v[200:201], v[40:41]
    v_pk_mul_f32 v[202:203], v[202:203], v[42:43]
    v_pk_mul_f32 v[204:205], v[204:205], v[44:45]
    v_pk_mul_f32 v[206:207], v[206:207], v[46:47]
    v_exp_f32 v192, v192
    v_exp_f32 v193, v193
    v_exp_f32 v194, v194
    v_exp_f32 v195, v195
    v_exp_f32 v196, v196
    v_exp_f32 v197, v197
    v_exp_f32 v198, v198
    v_exp_f32 v199, v199
    v_exp_f32 v200, v200
    v_exp_f32 v201, v201
    v_exp_f32 v202, v202
    v_exp_f32 v203, v203
    v_exp_f32 v204, v204
    v_exp_f32 v205, v205
    v_exp_f32 v206, v206
    v_exp_f32 v207, v207
    v_pk_add_f32 v[192:193], v[192:193], v[244:245]
    v_pk_add_f32 v[194:195], v[194:195], v[244:245]
    v_pk_add_f32 v[196:197], v[196:197], v[244:245]
    v_pk_add_f32 v[198:199], v[198:199], v[244:245]
    v_pk_add_f32 v[200:201], v[200:201], v[244:245]
    v_pk_add_f32 v[202:203], v[202:203], v[244:245]
    v_pk_add_f32 v[204:205], v[204:205], v[244:245]
    v_pk_add_f32 v[206:207], v[206:207], v[244:245]
    v_rcp_f32 v192, v192
    v_rcp_f32 v193, v193
    v_rcp_f32 v194, v194
    v_rcp_f32 v195, v195
    v_rcp_f32 v196, v196
    v_rcp_f32 v197, v197
    v_rcp_f32 v198, v198
    v_rcp_f32 v199, v199
    v_rcp_f32 v200, v200
    v_rcp_f32 v201, v201
    v_rcp_f32 v202, v202
    v_rcp_f32 v203, v203
    v_rcp_f32 v204, v204
    v_rcp_f32 v205, v205
    v_rcp_f32 v206, v206
    v_rcp_f32 v207, v207
    v_pk_mul_f32 v[32:33], v[32:33], v[192:193]
    v_pk_mul_f32 v[34:35], v[34:35], v[194:195]
    v_pk_mul_f32 v[36:37], v[36:37], v[196:197]
    v_pk_mul_f32 v[38:39], v[38:39], v[198:199]
    v_pk_mul_f32 v[40:41], v[40:41], v[200:201]
    v_pk_mul_f32 v[42:43], v[42:43], v[202:203]
    v_pk_mul_f32 v[44:45], v[44:45], v[204:205]
    v_pk_mul_f32 v[46:47], v[46:47], v[206:207]
    v_pk_add_f32 v[224:225], v[32:33], v[34:35]
    v_pk_mul_f32 v[226:227], v[32:33], v[32:33]
    v_pk_add_f32 v[228:229], v[36:37], v[38:39]
    v_pk_mul_f32 v[230:231], v[34:35], v[34:35]
    v_pk_fma_f32 v[226:227], v[36:37], v[36:37], v[226:227]
    v_pk_fma_f32 v[230:231], v[38:39], v[38:39], v[230:231]
    v_pk_fma_f32 v[226:227], v[40:41], v[40:41], v[226:227]
    v_pk_add_f32 v[224:225], v[224:225], v[40:41]
    v_pk_fma_f32 v[230:231], v[42:43], v[42:43], v[230:231]
    v_pk_add_f32 v[228:229], v[228:229], v[42:43]
    v_pk_fma_f32 v[226:227], v[44:45], v[44:45], v[226:227]
    v_pk_add_f32 v[224:225], v[224:225], v[44:45]
    v_pk_fma_f32 v[230:231], v[46:47], v[46:47], v[230:231]
    v_pk_add_f32 v[228:229], v[228:229], v[46:47]
    v_pk_add_f32 v[224:225], v[224:225], v[228:229]
    v_pk_add_f32 v[226:227], v[226:227], v[230:231]
    v_add_f32 v224, v224, v225
    v_add_f32 v225, v226, v227
    v_mov_b32 v226, v224
    v_mov_b32 v227, v225
    s_nop 0
    v_permlane32_swap_b32 v224, v226
    v_permlane32_swap_b32 v225, v227
    v_pk_add_f32 v[224:225], v[224:225], v[226:227]
    s_cmp_eq_u32 s32, 0
    s_cbranch_scc1 K1_NOPW
    ds_write_b64 v250, v[224:225]
K1_NOPW:
    s_waitcnt vmcnt(1)
    v_add_u32 v31, 1, v31
    s_waitcnt lgkmcnt(0)
    s_barrier
    ds_read_b64 v[228:229], v250
    s_lshl_b32 s34, s29, 2
    s_add_u32 s39, s34, s31
    s_mul_i32 s34, s39, 7168
    s_add_u32 s47, s34, 18874368
    s_lshl_b32 s35, s30, 1
    s_add_u32 s48, s35, s32
    s_lshl_b32 s35, s30, 9
    s_add_u32 s34, s47, s35
    ds_read_b64_tr_b16 v[176:177], v6 offset:0
    ds_read_b64_tr_b16 v[178:179], v6 offset:512
    ds_read_b64_tr_b16 v[180:181], v6 offset:8192
    ds_read_b64_tr_b16 v[182:183], v6 offset:8704
    ds_read_b64_tr_b16 v[184:185], v6 offset:16384
    ds_read_b64_tr_b16 v[186:187], v6 offset:16896
    ds_read_b64_tr_b16 v[188:189], v6 offset:24576
    ds_read_b64_tr_b16 v[190:191], v6 offset:25088
    ds_read_b64_tr_b16 v[192:193], v6 offset:32768
    ds_read_b64_tr_b16 v[194:195], v6 offset:33280
    ds_read_b64_tr_b16 v[196:197], v6 offset:40960
    ds_read_b64_tr_b16 v[198:199], v6 offset:41472
    s_cmp_lg_u32 s32, 0
    s_cbranch_scc1 K1_NOPUB
    s_waitcnt lgkmcnt(12)
    v_add_f32 v224, v224, v228
    v_add_f32 v226, v225, v229
    v_mov_b32 v225, v31
    v_mov_b32 v227, v31
    s_mov_b32 exec_hi, 0
    buffer_store_dwordx4 v[224:227], v24, s[16:19], s34 offen sc1
    s_mov_b64 exec, -1
K1_NOPUB:
    s_waitcnt lgkmcnt(10)
    v_mfma_f32_32x32x16_bf16 v[48:63], v[176:179], v[64:67], 0
    ds_read_b64_tr_b16 v[200:201], v6 offset:49152
    ds_read_b64_tr_b16 v[202:203], v6 offset:49664
    v_mfma_f32_16x16x32_bf16 v[220:223], v[232:235], v[176:179], v[220:223]
    s_waitcnt lgkmcnt(10)
    v_mfma_f32_32x32x16_bf16 v[48:63], v[180:183], v[80:83], v[48:63]
    ds_read_b64_tr_b16 v[204:205], v7 offset:0
    ds_read_b64_tr_b16 v[206:207], v7 offset:512
    v_mfma_f32_16x16x32_bf16 v[220:223], v[232:235], v[180:183], v[220:223]
    s_waitcnt lgkmcnt(10)
    v_mfma_f32_32x32x16_bf16 v[48:63], v[184:187], v[96:99], v[48:63]
    ds_read_b64_tr_b16 v[176:177], v8 offset:0
    ds_read_b64_tr_b16 v[178:179], v8 offset:512
    v_mfma_f32_16x16x32_bf16 v[220:223], v[232:235], v[184:187], v[220:223]
    s_waitcnt lgkmcnt(10)
    v_mfma_f32_32x32x16_bf16 v[48:63], v[188:191], v[112:115], v[48:63]
    ds_read_b64_tr_b16 v[180:181], v9 offset:0
    ds_read_b64_tr_b16 v[182:183], v9 offset:512
    v_mfma_f32_16x16x32_bf16 v[220:223], v[232:235], v[188:191], v[220:223]
    s_waitcnt lgkmcnt(10)
    v_mfma_f32_32x32x16_bf16 v[48:63], v[192:195], v[128:131], v[48:63]
    ds_read_b64_tr_b16 v[184:185], v7 offset:8192
    ds_read_b64_tr_b16 v[186:187], v7 offset:8704
    v_mfma_f32_16x16x32_bf16 v[220:223], v[232:235], v[192:195], v[220:223]
    s_waitcnt lgkmcnt(10)
    v_mfma_f32_32x32x16_bf16 v[48:63], v[196:199], v[144:147], v[48:63]
    ds_read_b64_tr_b16 v[188:189], v8 offset:8192
    ds_read_b64_tr_b16 v[190:191], v8 offset:8704
    v_mfma_f32_16x16x32_bf16 v[220:223], v[232:235], v[196:199], v[220:223]
    s_waitcnt lgkmcnt(10)
    v_mfma_f32_32x32x16_bf16 v[48:63], v[200:203], v[160:163], v[48:63]
    ds_read_b64_tr_b16 v[192:193], v9 offset:8192
    ds_read_b64_tr_b16 v[194:195], v9 offset:8704
    v_mfma_f32_16x16x32_bf16 v[220:223], v[232:235], v[200:203], v[220:223]
    s_waitcnt lgkmcnt(10)
    v_mfma_f32_32x32x16_bf16 v[48:63], v[204:207], v[68:71], v[48:63]
    ds_read_b64_tr_b16 v[196:197], v7 offset:16384
    ds_read_b64_tr_b16 v[198:199], v7 offset:16896
    s_waitcnt lgkmcnt(10)
    v_mfma_f32_32x32x16_bf16 v[48:63], v[176:179], v[72:75], v[48:63]
    ds_read_b64_tr_b16 v[200:201], v8 offset:16384
    ds_read_b64_tr_b16 v[202:203], v8 offset:16896
    s_waitcnt lgkmcnt(10)
    v_mfma_f32_32x32x16_bf16 v[48:63], v[180:183], v[76:79], v[48:63]
    ds_read_b64_tr_b16 v[204:205], v9 offset:16384
    ds_read_b64_tr_b16 v[206:207], v9 offset:16896
    ds_write_b32 v254, v220
    s_waitcnt lgkmcnt(11)
    v_mfma_f32_32x32x16_bf16 v[48:63], v[184:187], v[84:87], v[48:63]
    ds_read_b64_tr_b16 v[176:177], v7 offset:24576
    ds_read_b64_tr_b16 v[178:179], v7 offset:25088
    s_waitcnt lgkmcnt(11)
    v_mfma_f32_32x32x16_bf16 v[48:63], v[188:191], v[88:91], v[48:63]
    ds_read_b64_tr_b16 v[180:181], v8 offset:24576
    ds_read_b64_tr_b16 v[182:183], v8 offset:25088
    s_waitcnt lgkmcnt(11)
    v_mfma_f32_32x32x16_bf16 v[48:63], v[192:195], v[92:95], v[48:63]
    ds_read_b64_tr_b16 v[184:185], v9 offset:24576
    ds_read_b64_tr_b16 v[186:187], v9 offset:25088
    s_waitcnt lgkmcnt(11)
    v_mfma_f32_32x32x16_bf16 v[48:63], v[196:199], v[100:103], v[48:63]
    ds_read_b64_tr_b16 v[188:189], v7 offset:32768
    ds_read_b64_tr_b16 v[190:191], v7 offset:33280
    s_waitcnt lgkmcnt(11)
    v_mfma_f32_32x32x16_bf16 v[48:63], v[200:203], v[104:107], v[48:63]
    ds_read_b64_tr_b16 v[192:193], v8 offset:32768
    ds_read_b64_tr_b16 v[194:195], v8 offset:33280
    s_waitcnt lgkmcnt(11)
    v_mfma_f32_32x32x16_bf16 v[48:63], v[204:207], v[108:111], v[48:63]
    ds_read_b64_tr_b16 v[196:197], v9 offset:32768
    ds_read_b64_tr_b16 v[198:199], v9 offset:33280
    s_waitcnt lgkmcnt(10)
    v_mfma_f32_32x32x16_bf16 v[48:63], v[176:179], v[116:119], v[48:63]
    ds_read_b64_tr_b16 v[200:201], v7 offset:40960
    ds_read_b64_tr_b16 v[202:203], v7 offset:41472
    s_waitcnt lgkmcnt(10)
    v_mfma_f32_32x32x16_bf16 v[48:63], v[180:183], v[120:123], v[48:63]
    ds_read_b64_tr_b16 v[204:205], v8 offset:40960
    ds_read_b64_tr_b16 v[206:207], v8 offset:41472
    s_waitcnt lgkmcnt(10)
    v_mfma_f32_32x32x16_bf16 v[48:63], v[184:187], v[124:127], v[48:63]
    ds_read_b64_tr_b16 v[176:177], v9 offset:40960
    ds_read_b64_tr_b16 v[178:179], v9 offset:41472
    s_waitcnt lgkmcnt(15)
    s_barrier
    ds_read_b128 v[224:227], v255
    s_waitcnt lgkmcnt(11)
    v_mfma_f32_32x32x16_bf16 v[48:63], v[188:191], v[132:135], v[48:63]
    ds_read_b64_tr_b16 v[180:181], v7 offset:49152
    ds_read_b64_tr_b16 v[182:183], v7 offset:49664
    s_waitcnt lgkmcnt(11)
    v_mfma_f32_32x32x16_bf16 v[48:63], v[192:195], v[136:139], v[48:63]
    ds_read_b64_tr_b16 v[184:185], v8 offset:49152
    ds_read_b64_tr_b16 v[186:187], v8 offset:49664
    s_waitcnt lgkmcnt(11)
    v_mfma_f32_32x32x16_bf16 v[48:63], v[196:199], v[140:143], v[48:63]
    ds_read_b64_tr_b16 v[188:189], v9 offset:49152
    ds_read_b64_tr_b16 v[190:191], v9 offset:49664
    s_waitcnt lgkmcnt(11)
    v_mfma_f32_32x32x16_bf16 v[48:63], v[200:203], v[148:151], v[48:63]
    s_waitcnt lgkmcnt(6)
    v_add_f32 v224, v224, v225
    v_add_f32 v226, v226, v227
    v_add_f32 v224, v224, v226
    ds_write_b32 v252, v224
    ds_read_b128 v[208:211], v253 offset:0
    ds_read_b128 v[212:215], v253 offset:32
    ds_read_b128 v[216:219], v253 offset:64
    ds_read_b128 v[220:223], v253 offset:96
    s_waitcnt lgkmcnt(14)
    v_mfma_f32_32x32x16_bf16 v[48:63], v[204:207], v[152:155], v[48:63]
    s_waitcnt lgkmcnt(12)
    v_mfma_f32_32x32x16_bf16 v[48:63], v[176:179], v[156:159], v[48:63]
    s_waitcnt lgkmcnt(9)
    v_mfma_f32_32x32x16_bf16 v[48:63], v[180:183], v[164:167], v[48:63]
    s_waitcnt lgkmcnt(7)
    v_mfma_f32_32x32x16_bf16 v[48:63], v[184:187], v[168:171], v[48:63]
    s_waitcnt lgkmcnt(5)
    v_mfma_f32_32x32x16_bf16 v[48:63], v[188:191], v[172:175], v[48:63]
    ds_read_b128 v[148:151], v249 offset:0
    ds_read_b128 v[152:155], v249 offset:16
    ds_read_b128 v[156:159], v249 offset:32
    ds_read_b128 v[160:163], v249 offset:48
    s_mov_b32 s46, 0
    s_add_u32 s53, s47, 4096
    buffer_load_dwordx4 v[112:115], v24, s[16:19], s47 offen offset:0 sc1
    buffer_load_dwordx4 v[116:119], v24, s[16:19], s47 offen offset:1024 sc1
    buffer_load_dwordx4 v[120:123], v24, s[16:19], s47 offen offset:2048 sc1
    buffer_load_dwordx4 v[124:127], v24, s[16:19], s47 offen offset:3072 sc1
    buffer_load_dwordx4 v[128:131], v24, s[16:19], s53 offen offset:0 sc1
    buffer_load_dwordx4 v[132:135], v24, s[16:19], s53 offen offset:1024 sc1
    buffer_load_dwordx4 v[136:139], v24, s[16:19], s53 offen offset:2048 sc1
    s_waitcnt lgkmcnt(4)
    v_pk_fma_f32 v[48:49], v[208:209], v[240:241], v[48:49] op_sel:[0,0,0] op_sel_hi:[1,0,1] neg_lo:[1,0,0] neg_hi:[1,0,0]
    v_pk_fma_f32 v[50:51], v[210:211], v[240:241], v[50:51] op_sel:[0,0,0] op_sel_hi:[1,0,1] neg_lo:[1,0,0] neg_hi:[1,0,0]
    v_pk_fma_f32 v[52:53], v[212:213], v[240:241], v[52:53] op_sel:[0,0,0] op_sel_hi:[1,0,1] neg_lo:[1,0,0] neg_hi:[1,0,0]
    v_pk_fma_f32 v[54:55], v[214:215], v[240:241], v[54:55] op_sel:[0,0,0] op_sel_hi:[1,0,1] neg_lo:[1,0,0] neg_hi:[1,0,0]
    v_pk_fma_f32 v[56:57], v[216:217], v[240:241], v[56:57] op_sel:[0,0,0] op_sel_hi:[1,0,1] neg_lo:[1,0,0] neg_hi:[1,0,0]
    v_pk_fma_f32 v[58:59], v[218:219], v[240:241], v[58:59] op_sel:[0,0,0] op_sel_hi:[1,0,1] neg_lo:[1,0,0] neg_hi:[1,0,0]
    v_pk_fma_f32 v[60:61], v[220:221], v[240:241], v[60:61] op_sel:[0,0,0] op_sel_hi:[1,0,1] neg_lo:[1,0,0] neg_hi:[1,0,0]
    v_pk_fma_f32 v[62:63], v[222:223], v[240:241], v[62:63] op_sel:[0,0,0] op_sel_hi:[1,0,1] neg_lo:[1,0,0] neg_hi:[1,0,0]
    v_pk_mul_f32 v[48:49], v[48:49], v[240:241] op_sel:[0,1] op_sel_hi:[1,1]
    v_pk_mul_f32 v[50:51], v[50:51], v[240:241] op_sel:[0,1] op_sel_hi:[1,1]
    v_pk_mul_f32 v[52:53], v[52:53], v[240:241] op_sel:[0,1] op_sel_hi:[1,1]
    v_pk_mul_f32 v[54:55], v[54:55], v[240:241] op_sel:[0,1] op_sel_hi:[1,1]
    v_pk_mul_f32 v[56:57], v[56:57], v[240:241] op_sel:[0,1] op_sel_hi:[1,1]
    v_pk_mul_f32 v[58:59], v[58:59], v[240:241] op_sel:[0,1] op_sel_hi:[1,1]
    v_pk_mul_f32 v[60:61], v[60:61], v[240:241] op_sel:[0,1] op_sel_hi:[1,1]
    v_pk_mul_f32 v[62:63], v[62:63], v[240:241] op_sel:[0,1] op_sel_hi:[1,1]
    v_pk_mul_f32 v[192:193], v[48:49], v[48:49]
    v_pk_mul_f32 v[194:195], v[50:51], v[50:51]
    v_pk_mul_f32 v[196:197], v[52:53], v[52:53]
    v_pk_mul_f32 v[198:199], v[54:55], v[54:55]
    v_pk_mul_f32 v[200:201], v[56:57], v[56:57]
    v_pk_mul_f32 v[202:203], v[58:59], v[58:59]
    v_pk_mul_f32 v[204:205], v[60:61], v[60:61]
    v_pk_mul_f32 v[206:207], v[62:63], v[62:63]
    v_pk_fma_f32 v[192:193], v[192:193], v[242:243], v[242:243] op_sel:[0,1,0] op_sel_hi:[1,1,0]
    v_pk_fma_f32 v[194:195], v[194:195], v[242:243], v[242:243] op_sel:[0,1,0] op_sel_hi:[1,1,0]
    v_pk_fma_f32 v[196:197], v[196:197], v[242:243], v[242:243] op_sel:[0,1,0] op_sel_hi:[1,1,0]
    v_pk_fma_f32 v[198:199], v[198:199], v[242:243], v[242:243] op_sel:[0,1,0] op_sel_hi:[1,1,0]
    v_pk_fma_f32 v[200:201], v[200:201], v[242:243], v[242:243] op_sel:[0,1,0] op_sel_hi:[1,1,0]
    v_pk_fma_f32 v[202:203], v[202:203], v[242:243], v[242:243] op_sel:[0,1,0] op_sel_hi:[1,1,0]
    v_pk_fma_f32 v[204:205], v[204:205], v[242:243], v[242:243] op_sel:[0,1,0] op_sel_hi:[1,1,0]
    v_pk_fma_f32 v[206:207], v[206:207], v[242:243], v[242:243] op_sel:[0,1,0] op_sel_hi:[1,1,0]
    v_pk_mul_f32 v[192:193], v[192:193], v[48:49]
    v_pk_mul_f32 v[194:195], v[194:195], v[50:51]
    v_pk_mul_f32 v[196:197], v[196:197], v[52:53]
    v_pk_mul_f32 v[198:199], v[198:199], v[54:55]
    v_pk_mul_f32 v[200:201], v[200:201], v[56:57]
    v_pk_mul_f32 v[202:203], v[202:203], v[58:59]
    v_pk_mul_f32 v[204:205], v[204:205], v[60:61]
    v_pk_mul_f32 v[206:207], v[206:207], v[62:63]
    v_exp_f32 v192, v192
    v_exp_f32 v193, v193
    v_exp_f32 v194, v194
    v_exp_f32 v195, v195
    v_exp_f32 v196, v196
    v_exp_f32 v197, v197
    v_exp_f32 v198, v198
    v_exp_f32 v199, v199
    v_exp_f32 v200, v200
    v_exp_f32 v201, v201
    v_exp_f32 v202, v202
    v_exp_f32 v203, v203
    v_exp_f32 v204, v204
    v_exp_f32 v205, v205
    v_exp_f32 v206, v206
    v_exp_f32 v207, v207
    v_pk_add_f32 v[192:193], v[192:193], v[244:245]
    v_pk_add_f32 v[194:195], v[194:195], v[244:245]
    v_pk_add_f32 v[196:197], v[196:197], v[244:245]
    v_pk_add_f32 v[198:199], v[198:199], v[244:245]
    v_pk_add_f32 v[200:201], v[200:201], v[244:245]
    v_pk_add_f32 v[202:203], v[202:203], v[244:245]
    v_pk_add_f32 v[204:205], v[204:205], v[244:245]
    v_pk_add_f32 v[206:207], v[206:207], v[244:245]
    v_rcp_f32 v192, v192
    v_rcp_f32 v193, v193
    v_rcp_f32 v194, v194
    v_rcp_f32 v195, v195
    v_rcp_f32 v196, v196
    v_rcp_f32 v197, v197
    v_rcp_f32 v198, v198
    v_rcp_f32 v199, v199
    v_rcp_f32 v200, v200
    v_rcp_f32 v201, v201
    v_rcp_f32 v202, v202
    v_rcp_f32 v203, v203
    v_rcp_f32 v204, v204
    v_rcp_f32 v205, v205
    v_rcp_f32 v206, v206
    v_rcp_f32 v207, v207
    v_pk_mul_f32 v[48:49], v[48:49], v[192:193]
    v_pk_mul_f32 v[50:51], v[50:51], v[194:195]
    v_pk_mul_f32 v[52:53], v[52:53], v[196:197]
    v_pk_mul_f32 v[54:55], v[54:55], v[198:199]
    v_pk_mul_f32 v[56:57], v[56:57], v[200:201]
    v_pk_mul_f32 v[58:59], v[58:59], v[202:203]
    v_pk_mul_f32 v[60:61], v[60:61], v[204:205]
    v_pk_mul_f32 v[62:63], v[62:63], v[206:207]
    v_cvt_pk_bf16_f32 v64, v48, v49
    v_cvt_pk_bf16_f32 v65, v50, v51
    v_cvt_pk_bf16_f32 v68, v52, v53
    v_cvt_pk_bf16_f32 v69, v54, v55
    v_cvt_pk_bf16_f32 v66, v56, v57
    v_cvt_pk_bf16_f32 v67, v58, v59
    v_cvt_pk_bf16_f32 v70, v60, v61
    v_cvt_pk_bf16_f32 v71, v62, v63
    v_bfe_u32 v2, v1, 4, 1
    v_mul_u32_u24 v2, 28672, v2
    v_lshrrev_b32 v7, 5, v1
    v_lshl_add_u32 v2, v7, 8, v2
    v_and_b32 v7, 15, v1
    v_lshl_add_u32 v2, v7, 4, v2
    s_mul_i32 s34, s39, 57344
    s_lshl_b32 s35, s48, 10
    s_add_u32 s34, s34, s35
    s_add_u32 s54, s34, 4194304
    buffer_store_dwordx4 v[64:67], v2, s[16:19], s54 offen sc1
    buffer_store_dwordx4 v[68:71], v2, s[16:19], s54 offen offset:512 sc1
    s_waitcnt lgkmcnt(0)
    v_lshlrev_b32 v72, 16, v26
    v_and_b32 v73, 0xffff0000, v26
    v_lshlrev_b32 v74, 16, v27
    v_and_b32 v75, 0xffff0000, v27
    v_lshlrev_b32 v76, 16, v28
    v_and_b32 v77, 0xffff0000, v28
    v_lshlrev_b32 v78, 16, v29
    v_and_b32 v79, 0xffff0000, v29
    v_sub_f32 v72, v72, v148
    v_sub_f32 v73, v73, v150
    v_sub_f32 v74, v74, v152
    v_sub_f32 v75, v75, v154
    v_sub_f32 v76, v76, v156
    v_sub_f32 v77, v77, v158
    v_sub_f32 v78, v78, v160
    v_sub_f32 v79, v79, v162
    v_cvt_pk_bf16_f32 v84, v72, v73
    v_cvt_pk_bf16_f32 v85, v74, v75
    v_cvt_pk_bf16_f32 v86, v76, v77
    v_cvt_pk_bf16_f32 v87, v78, v79
    v_lshlrev_b32 v72, 16, v84
    v_and_b32 v73, 0xffff0000, v84
    v_lshlrev_b32 v74, 16, v85
    v_and_b32 v75, 0xffff0000, v85
    v_lshlrev_b32 v76, 16, v86
    v_and_b32 v77, 0xffff0000, v86
    v_lshlrev_b32 v78, 16, v87
    v_and_b32 v79, 0xffff0000, v87
    v_mul_f32 v72, v72, v149
    v_mul_f32 v73, v73, v151
    v_mul_f32 v74, v74, v153
    v_mul_f32 v75, v75, v155
    v_mul_f32 v76, v76, v157
    v_mul_f32 v77, v77, v159
    v_mul_f32 v78, v78, v161
    v_mul_f32 v79, v79, v163
    v_cvt_pk_bf16_f32 v84, v79, v78
    v_cvt_pk_bf16_f32 v85, v77, v76
    v_cvt_pk_bf16_f32 v86, v75, v74
    v_cvt_pk_bf16_f32 v87, v73, v72
    v_lshrrev_b32 v3, 5, v1
    v_and_b32 v7, 15, v1
    v_lshl_add_u32 v3, v3, 4, v7
    v_mul_u32_u24 v3, 4096, v3
    v_bfe_u32 v7, v1, 4, 1
    v_lshlrev_b32 v7, 4, v7
    v_sub_u32 v3, v3, v7
    v_add_u32 v3, 16, v3
    s_lshl_b32 s34, s43, 4
    s_add_u32 s34, s34, s33
    s_sub_u32 s34, 2032, s34
    s_lshl_b32 s34, s34, 1
    s_mul_i32 s35, s30, 131072
    s_add_u32 s34, s34, s35
    s_add_u32 s55, s34, 12582912
    v_and_b32 v6, 31, v1
    v_mul_u32_u24 v6, 72, v6
    v_lshrrev_b32 v7, 5, v1
    v_lshl_add_u32 v6, v7, 3, v6
    s_mul_i32 s34, s28, 2304
    v_add_u32 v6, s34, v6
    v_lshrrev_b32 v7, 4, v1
    v_bfe_u32 v8, v1, 2, 2
    v_lshl_add_u32 v7, v7, 3, v8
    v_mul_u32_u24 v7, 72, v7
    v_and_b32 v8, 3, v1
    v_lshl_add_u32 v7, v8, 3, v7
    v_add_u32 v7, s34, v7
    s_lshl_b32 s34, s48, 1
    s_add_u32 s34, s34, 0
    s_mul_i32 s35, s34, 37
    s_lshr_b32 s35, s35, 8
    s_mul_i32 s40, s35, 7
    s_sub_u32 s34, s34, s40
    s_lshl_b32 s35, s35, 6
    s_add_u32 s35, s35, s39
    s_mul_i32 s35, s35, 7
    s_add_u32 s34, s34, s35
    s_lshl_b32 s50, s34, 10
    s_lshl_b32 s34, s48, 1
    s_add_u32 s34, s34, 1
    s_mul_i32 s35, s34, 37
    s_lshr_b32 s35, s35, 8
    s_mul_i32 s40, s35, 7
    s_sub_u32 s34, s34, s40
    s_lshl_b32 s35, s35, 6
    s_add_u32 s35, s35, s39
    s_mul_i32 s35, s35, 7
    s_add_u32 s34, s34, s35
    s_lshl_b32 s51, s34, 10
    s_waitcnt vmcnt(2)
    s_branch K1_POLL2C
K1_POLL2:
    s_waitcnt vmcnt(0)
K1_POLL2C:
    v_mov_b32 v8, 0
    v_xor_b32 v113, v31, v113
    v_xor_b32 v115, v31, v115
    v_or3_b32 v8, v8, v113, v115
    v_xor_b32 v117, v31, v117
    v_xor_b32 v119, v31, v119
    v_or3_b32 v8, v8, v117, v119
    v_xor_b32 v121, v31, v121
    v_xor_b32 v123, v31, v123
    v_or3_b32 v8, v8, v121, v123
    v_xor_b32 v125, v31, v125
    v_xor_b32 v127, v31, v127
    v_or3_b32 v8, v8, v125, v127
    v_xor_b32 v129, v31, v129
    v_xor_b32 v131, v31, v131
    v_or3_b32 v8, v8, v129, v131
    v_xor_b32 v133, v31, v133
    v_xor_b32 v135, v31, v135
    v_or3_b32 v8, v8, v133, v135
    v_xor_b32 v137, v31, v137
    v_xor_b32 v139, v31, v139
    v_or3_b32 v8, v8, v137, v139
    v_cmp_ne_u32 vcc, 0, v8
    s_nop 4
    s_cbranch_vccz K1_POLL2_OK
    s_sleep 1
    buffer_load_dwordx4 v[112:115], v24, s[16:19], s47 offen offset:0 sc1
    buffer_load_dwordx4 v[116:119], v24, s[16:19], s47 offen offset:1024 sc1
    buffer_load_dwordx4 v[120:123], v24, s[16:19], s47 offen offset:2048 sc1
    buffer_load_dwordx4 v[124:127], v24, s[16:19], s47 offen offset:3072 sc1
    buffer_load_dwordx4 v[128:131], v24, s[16:19], s53 offen offset:0 sc1
    buffer_load_dwordx4 v[132:135], v24, s[16:19], s53 offen offset:1024 sc1
    buffer_load_dwordx4 v[136:139], v24, s[16:19], s53 offen offset:2048 sc1
    s_add_u32 s46, s46, 1
    s_cmp_lt_u32 s46, 0x40000
    s_cbranch_scc1 K1_POLL2
    s_waitcnt vmcnt(0)
K1_POLL2_OK:
    s_or_b32 s34, s30, s28
    s_cmp_lg_u32 s34, 0
    s_cbranch_scc1 K1_NOTAGW
    s_mov_b64 exec, 1
    buffer_store_dword v31, v30, s[16:19], s49 offen sc1
    s_mov_b64 exec, -1
K1_NOTAGW:
    buffer_store_dwordx4 v[84:87], v3, s[16:19], s55 offen sc1
    v_add_f32 v112, v112, v116
    v_add_f32 v114, v114, v118
    v_add_f32 v120, v120, v124
    v_add_f32 v122, v122, v126
    v_add_f32 v128, v128, v132
    v_add_f32 v130, v130, v134
    v_add_f32 v112, v112, v120
    v_add_f32 v114, v114, v122
    v_add_f32 v128, v128, v136
    v_add_f32 v130, v130, v138
    v_add_f32 v112, v112, v128
    v_add_f32 v114, v114, v130
    v_mov_b32 v116, v112
    v_mov_b32 v117, v114
    v_mov_b32 v118, v116
    v_mov_b32 v119, v117
    s_nop 0
    v_permlane32_swap_b32 v116, v118
    v_permlane32_swap_b32 v117, v119
    v_add_f32 v116, v116, v118
    v_add_f32 v117, v117, v119
    v_mul_f32 v116, 0x3a924925, v116
    v_mul_f32 v117, 0x3a924925, v117
    v_fma_f32 v117, -v116, v116, v117
    v_max_f32 v117, 0, v117
    v_cvt_pk_bf16_f32 v116, v116, v116
    v_lshlrev_b32 v116, 16, v116
    v_cvt_pk_bf16_f32 v117, v117, v117
    v_lshlrev_b32 v117, 16, v117
    v_add_f32 v117, 0x3727c5ac, v117
    v_cvt_pk_bf16_f32 v117, v117, v117
    v_lshlrev_b32 v117, 16, v117
    v_sqrt_f32 v117, v117
    s_nop 0
    v_cvt_pk_bf16_f32 v117, v117, v117
    v_lshlrev_b32 v117, 16, v117
    v_rcp_f32 v117, v117
    s_nop 0
    v_mul_f32 v116, v116, v117
    v_pk_fma_f32 v[32:33], v[32:33], v[116:117], v[116:117] op_sel:[0,1,0] op_sel_hi:[1,1,0] neg_lo:[0,0,1] neg_hi:[0,0,1]
    v_pk_fma_f32 v[34:35], v[34:35], v[116:117], v[116:117] op_sel:[0,1,0] op_sel_hi:[1,1,0] neg_lo:[0,0,1] neg_hi:[0,0,1]
    v_pk_fma_f32 v[36:37], v[36:37], v[116:117], v[116:117] op_sel:[0,1,0] op_sel_hi:[1,1,0] neg_lo:[0,0,1] neg_hi:[0,0,1]
    v_pk_fma_f32 v[38:39], v[38:39], v[116:117], v[116:117] op_sel:[0,1,0] op_sel_hi:[1,1,0] neg_lo:[0,0,1] neg_hi:[0,0,1]
    v_pk_fma_f32 v[40:41], v[40:41], v[116:117], v[116:117] op_sel:[0,1,0] op_sel_hi:[1,1,0] neg_lo:[0,0,1] neg_hi:[0,0,1]
    v_pk_fma_f32 v[42:43], v[42:43], v[116:117], v[116:117] op_sel:[0,1,0] op_sel_hi:[1,1,0] neg_lo:[0,0,1] neg_hi:[0,0,1]
    v_pk_fma_f32 v[44:45], v[44:45], v[116:117], v[116:117] op_sel:[0,1,0] op_sel_hi:[1,1,0] neg_lo:[0,0,1] neg_hi:[0,0,1]
    v_pk_fma_f32 v[46:47], v[46:47], v[116:117], v[116:117] op_sel:[0,1,0] op_sel_hi:[1,1,0] neg_lo:[0,0,1] neg_hi:[0,0,1]
    v_cvt_pk_bf16_f32 v96, v32, v33
    v_cvt_pk_bf16_f32 v97, v34, v35
    v_cvt_pk_bf16_f32 v98, v36, v37
    v_cvt_pk_bf16_f32 v99, v38, v39
    v_cvt_pk_bf16_f32 v100, v40, v41
    v_cvt_pk_bf16_f32 v101, v42, v43
    v_cvt_pk_bf16_f32 v102, v44, v45
    v_cvt_pk_bf16_f32 v103, v46, v47
    ds_write_b64 v6, v[96:97] offset:0
    ds_write_b64 v6, v[98:99] offset:16
    ds_write_b64 v6, v[100:101] offset:32
    ds_write_b64 v6, v[102:103] offset:48
    s_waitcnt lgkmcnt(0)
    ds_read_b64_tr_b16 v[104:105], v7 offset:0
    ds_read_b64_tr_b16 v[106:107], v7 offset:288
    ds_read_b64_tr_b16 v[108:109], v7 offset:32
    ds_read_b64_tr_b16 v[110:111], v7 offset:320
    s_waitcnt lgkmcnt(2)
    buffer_store_dwordx4 v[104:107], v24, s[16:19], s50 offen sc1
    s_waitcnt lgkmcnt(0)
    buffer_store_dwordx4 v[108:111], v24, s[16:19], s51 offen sc1
    s_endpgm
K1_AUX:
    s_sub_u32 s29, s2, 224
    s_waitcnt lgkmcnt(0)
    s_load_dwordx2 s[32:33], s[0:1], 8
    s_load_dwordx2 s[36:37], s[0:1], 16
    s_load_dwordx2 s[40:41], s[0:1], 24
    s_load_dwordx2 s[44:45], s[0:1], 32
    s_load_dwordx2 s[8:9], s[0:1], 40
    s_mov_b32 s34, 229376
    s_mov_b32 s35, 0x00020000
    s_mov_b32 s38, 229376
    s_mov_b32 s39, 0x00020000
    s_mov_b32 s42, 229376
    s_mov_b32 s43, 0x00020000
    s_mov_b32 s46, 229376
    s_mov_b32 s47, 0x00020000
    s_mov_b32 s10, 896
    s_mov_b32 s11, 0x00020000
    v_mov_b32 v30, 0
    v_lshlrev_b32 v3, 4, v1
    s_mul_i32 s56, s29, 28672
    s_lshl_b32 s57, s28, 10
    s_add_u32 s56, s56, s57
    s_and_b32 s30, s28, 3
    s_lshr_b32 s31, s28, 2
    s_mul_i32 s12, s31, 66176
    v_and_b32 v2, 255, v0
    v_lshlrev_b32 v4, 4, v2
    v_lshlrev_b32 v2, 1, v2
    s_mul_i32 s13, s29, 6
    s_add_u32 s13, s13, s31
    v_and_b32 v25, 15, v1
    v_lshrrev_b32 v26, 4, v1
    s_waitcnt lgkmcnt(0)
    s_add_u32 s48, s13, 0
    s_lshl_b32 s49, s48, 2
    s_add_u32 s49, s49, 2
    s_lshl_b32 s48, s49, 8
    buffer_load_ushort v216, v30, s[8:11], s49 offen
    buffer_load_ushort v200, v2, s[32:35], s48 offen
    buffer_load_ushort v201, v2, s[36:39], s48 offen
    buffer_load_ushort v202, v2, s[40:43], s48 offen
    buffer_load_ushort v203, v2, s[44:47], s48 offen
    s_add_u32 s48, s13, 2
    s_lshl_b32 s49, s48, 2
    s_add_u32 s49, s49, 2
    s_lshl_b32 s48, s49, 8
    buffer_load_ushort v217, v30, s[8:11], s49 offen
    buffer_load_ushort v204, v2, s[32:35], s48 offen
    buffer_load_ushort v205, v2, s[36:39], s48 offen
    buffer_load_ushort v206, v2, s[40:43], s48 offen
    buffer_load_ushort v207, v2, s[44:47], s48 offen
    s_add_u32 s48, s13, 4
    s_lshl_b32 s49, s48, 2
    s_add_u32 s49, s49, 2
    s_lshl_b32 s48, s49, 8
    buffer_load_ushort v218, v30, s[8:11], s49 offen
    buffer_load_ushort v208, v2, s[32:35], s48 offen
    buffer_load_ushort v209, v2, s[36:39], s48 offen
    buffer_load_ushort v210, v2, s[40:43], s48 offen
    buffer_load_ushort v211, v2, s[44:47], s48 offen
    s_lshl_b32 s50, s29, 3
    s_add_u32 s50, s50, s28
    s_mul_i32 s51, s50, 896
    s_lshl_b32 s50, s50, 15
    v_lshlrev_b32 v22, 7, v1
    v_min_u32 v23, 6, v1
    v_lshlrev_b32 v23, 7, v23
    v_add_u32 v24, 62016, v4
    v_add_u32 v24, s12, v24
    s_mov_b32 s15, 0
    s_waitcnt vmcnt(10)
    buffer_load_dword v16, v23, s[32:35], s51 offen
    buffer_load_dword v17, v23, s[36:39], s51 offen
    buffer_load_dword v18, v23, s[40:43], s51 offen
    buffer_load_dword v19, v23, s[44:47], s51 offen
    s_add_u32 m0, s57, 132352
    s_add_u32 s48, s56, 0
    buffer_load_dwordx4 v3, s[24:27], s48 offen lds
    s_add_u32 m0, s57, 140544
    s_add_u32 s48, s56, 8192
    buffer_load_dwordx4 v3, s[24:27], s48 offen lds
    s_add_u32 m0, s57, 148736
    s_add_u32 s48, s56, 16384
    buffer_load_dwordx4 v3, s[24:27], s48 offen lds
    v_mov_b32 v220, 0
    v_mov_b32 v221, 0
    v_mov_b32 v222, 0
    v_mov_b32 v223, 0
    v_lshlrev_b32 v224, 4, v1
    s_lshr_b32 s48, s50, 5
    s_add_u32 s48, s48, 18087936
    buffer_store_dwordx4 v[220:223], v224, s[16:19], s48 offen sc1
    s_waitcnt vmcnt(8)
    s_cmp_lg_u32 s31, 0
    s_cbranch_scc1 K1A_LOOP
    s_add_u32 m0, s57, 156928
    s_add_u32 s48, s56, 24576
    buffer_load_dwordx4 v3, s[24:27], s48 offen lds
K1A_LOOP:
    v_mov_b32 v5, v200
    v_mov_b32 v6, v201
    v_mov_b32 v7, v202
    v_mov_b32 v8, v203
    v_lshlrev_b32 v9, 16, v216
    v_mov_b32 v200, v204
    v_mov_b32 v201, v205
    v_mov_b32 v202, v206
    v_mov_b32 v203, v207
    v_mov_b32 v204, v208
    v_mov_b32 v205, v209
    v_mov_b32 v206, v210
    v_mov_b32 v207, v211
    v_mov_b32 v216, v217
    v_mov_b32 v217, v218
    v_lshlrev_b32 v5, 16, v5
    v_mul_f32 v12, 0x3fb8aa3b, v9
    v_mov_b32 v14, 0x3fb8aa3b
    v_fma_f32 v13, v9, v14, -v12
    v_fmac_f32 v13, 0x32a57060, v9
    v_exp_f32 v12, v12
    v_mul_f32 v13, 0x3f317218, v13
    v_fma_f32 v9, v12, v13, v12
    v_cvt_pk_bf16_f32 v9, v9, v9
    v_lshlrev_b32 v9, 16, v9
    v_mul_f32 v12, 0x3fb8aa3b, v5
    v_mov_b32 v14, 0x3fb8aa3b
    v_fma_f32 v13, v5, v14, -v12
    v_fmac_f32 v13, 0x32a57060, v5
    v_exp_f32 v12, v12
    v_mul_f32 v13, 0x3f317218, v13
    v_fma_f32 v5, v12, v13, v12
    v_cvt_pk_bf16_f32 v5, v5, v5
    v_lshlrev_b32 v5, 16, v5
    v_lshlrev_b32 v6, 16, v6
    v_lshlrev_b32 v7, 16, v7
    v_lshlrev_b32 v8, 16, v8
    v_mul_f32 v5, -v5, v9
    v_mul_f32 v6, v6, v9
    v_mul_f32 v66, v7, v9
    v_mul_f32 v67, v8, v9
    v_mul_f32 v66, 0x42800000, v66
    v_mul_f32 v67, 0x42800000, v67
    v_mul_f32 v27, 0x3fb8aa3b, v5
    v_mul_f32 v35, 0x3e22f983, v6
    v_exp_f32 v27, v27
    v_cos_f32 v34, v35
    v_sin_f32 v35, v35
    v_mul_f32 v28, 0x4138aa3b, v5
    v_mul_f32 v51, 0x3fa2f983, v6
    v_exp_f32 v28, v28
    v_cos_f32 v50, v51
    v_sin_f32 v51, v51
    v_mul_f32 v29, 0x4338aa3b, v5
    v_mul_f32 v85, 0x41a2f983, v6
    v_exp_f32 v29, v29
    v_cos_f32 v84, v85
    v_sin_f32 v85, v85
    v_mul_f32 v34, v34, v27
    v_mul_f32 v35, v35, v27
    v_mul_f32 v50, v50, v28
    v_mul_f32 v51, v51, v28
    v_mul_f32 v84, v84, v29
    v_mul_f32 v85, v85, v29
    s_mul_i32 s48, s30, 15504
    s_add_u32 s48, s48, s12
    v_lshlrev_b32 v11, 2, v1
    v_add_u32 v11, s48, v11
    v_mul_f32 v36, v34, v34
    v_add_f32 v37, v34, v34
    v_mul_f32 v52, v50, v50
    v_add_f32 v53, v50, v50
    v_mul_f32 v86, v84, v84
    v_add_f32 v87, v84, v84
    v_fma_f32 v36, -v35, v35, v36
    v_mul_f32 v37, v37, v35
    v_fma_f32 v52, -v51, v51, v52
    v_mul_f32 v53, v53, v51
    v_fma_f32 v86, -v85, v85, v86
    v_mul_f32 v87, v87, v85
    v_mov_b32 v30, 0x3c00
    ds_write_b32 v11, v30 offset:11152
    v_cvt_pk_f16_f32 v120, v66, -v67
    ds_write_b32 v11, v120 offset:0
    v_cvt_pk_f16_f32 v105, v50, v51
    ds_write_b32 v11, v105 offset:11424
    v_cvt_pk_f16_f32 v97, v34, -v35
    v_cvt_pk_f16_f32 v180, v84, -v85
    v_mul_f32 v40, v36, v36
    v_add_f32 v41, v36, v36
    v_mul_f32 v56, v52, v52
    v_add_f32 v57, v52, v52
    v_mul_f32 v88, v86, v86
    v_add_f32 v89, v86, v86
    v_fma_f32 v40, -v37, v37, v40
    v_mul_f32 v41, v41, v37
    v_fma_f32 v56, -v53, v53, v56
    v_mul_f32 v57, v57, v53
    v_fma_f32 v88, -v87, v87, v88
    v_mul_f32 v89, v89, v87
    v_cvt_pk_f16_f32 v106, v52, v53
    ds_write_b32 v11, v106 offset:11696
    v_cvt_pk_f16_f32 v98, v36, -v37
    v_cvt_pk_f16_f32 v181, v86, -v87
    v_mul_f32 v64, v56, v56
    v_add_f32 v65, v56, v56
    v_mul_f32 v90, v88, v88
    v_add_f32 v91, v88, v88
    v_fma_f32 v64, -v57, v57, v64
    v_mul_f32 v65, v65, v57
    v_fma_f32 v90, -v89, v89, v90
    v_mul_f32 v91, v91, v89
    v_cvt_pk_f16_f32 v108, v56, v57
    ds_write_b32 v11, v108 offset:12240
    v_cvt_pk_f16_f32 v100, v40, -v41
    v_cvt_pk_f16_f32 v182, v88, -v89
    v_pk_mul_f16 v121, v120, v180 op_sel:[0,0] op_sel_hi:[1,0]
    v_pk_mul_f16 v122, v120, v181 op_sel:[0,0] op_sel_hi:[1,0]
    v_pk_mul_f16 v99, v98, v97 op_sel:[0,0] op_sel_hi:[1,0]
    v_pk_mul_f16 v107, v106, v105 op_sel:[0,0] op_sel_hi:[1,0]
    v_pk_mul_f16 v124, v120, v182 op_sel:[0,0] op_sel_hi:[1,0]
    v_pk_mul_f16 v101, v100, v97 op_sel:[0,0] op_sel_hi:[1,0]
    v_pk_mul_f16 v102, v100, v98 op_sel:[0,0] op_sel_hi:[1,0]
    v_pk_mul_f16 v109, v108, v105 op_sel:[0,0] op_sel_hi:[1,0]
    v_pk_mul_f16 v110, v108, v106 op_sel:[0,0] op_sel_hi:[1,0]
    v_pk_fma_f16 v121, v120, v180, v121 op_sel:[1,1,0] op_sel_hi:[0,1,1] neg_lo:[1,0,0]
    v_pk_fma_f16 v122, v120, v181, v122 op_sel:[1,1,0] op_sel_hi:[0,1,1] neg_lo:[1,0,0]
    v_pk_fma_f16 v99, v98, v97, v99 op_sel:[1,1,0] op_sel_hi:[0,1,1] neg_lo:[1,0,0]
    v_pk_fma_f16 v107, v106, v105, v107 op_sel:[1,1,0] op_sel_hi:[0,1,1] neg_lo:[1,0,0]
    v_pk_fma_f16 v124, v120, v182, v124 op_sel:[1,1,0] op_sel_hi:[0,1,1] neg_lo:[1,0,0]
    v_pk_fma_f16 v101, v100, v97, v101 op_sel:[1,1,0] op_sel_hi:[0,1,1] neg_lo:[1,0,0]
    v_pk_fma_f16 v102, v100, v98, v102 op_sel:[1,1,0] op_sel_hi:[0,1,1] neg_lo:[1,0,0]
    v_pk_fma_f16 v109, v108, v105, v109 op_sel:[1,1,0] op_sel_hi:[0,1,1] neg_lo:[1,0,0]
    v_pk_fma_f16 v110, v108, v106, v110 op_sel:[1,1,0] op_sel_hi:[0,1,1] neg_lo:[1,0,0]
    ds_write_b32 v11, v121 offset:2176
    ds_write_b32 v11, v122 offset:4352
    ds_write_b32 v11, v107 offset:11968
    ds_write_b32 v11, v124 offset:6528
    ds_write_b32 v11, v109 offset:12512
    ds_write_b32 v11, v110 offset:12784
    v_cvt_pk_f16_f32 v112, v64, v65
    ds_write_b32 v11, v112 offset:13328
    v_cvt_pk_f16_f32 v138, v90, -v91
    v_pk_mul_f16 v123, v121, v181 op_sel:[0,0] op_sel_hi:[1,0]
    v_pk_mul_f16 v125, v121, v182 op_sel:[0,0] op_sel_hi:[1,0]
    v_pk_mul_f16 v126, v122, v182 op_sel:[0,0] op_sel_hi:[1,0]
    v_pk_mul_f16 v103, v100, v99 op_sel:[0,0] op_sel_hi:[1,0]
    v_pk_mul_f16 v111, v108, v107 op_sel:[0,0] op_sel_hi:[1,0]
    v_pk_mul_f16 v128, v120, v138 op_sel:[0,0] op_sel_hi:[1,0]
    v_pk_mul_f16 v129, v121, v138 op_sel:[0,0] op_sel_hi:[1,0]
    v_pk_mul_f16 v130, v122, v138 op_sel:[0,0] op_sel_hi:[1,0]
    v_pk_mul_f16 v132, v124, v138 op_sel:[0,0] op_sel_hi:[1,0]
    v_pk_mul_f16 v113, v112, v105 op_sel:[0,0] op_sel_hi:[1,0]
    v_pk_mul_f16 v114, v112, v106 op_sel:[0,0] op_sel_hi:[1,0]
    v_pk_mul_f16 v115, v112, v107 op_sel:[0,0] op_sel_hi:[1,0]
    v_pk_mul_f16 v116, v112, v108 op_sel:[0,0] op_sel_hi:[1,0]
    v_pk_mul_f16 v117, v112, v109 op_sel:[0,0] op_sel_hi:[1,0]
    v_pk_mul_f16 v118, v112, v110 op_sel:[0,0] op_sel_hi:[1,0]
    v_pk_fma_f16 v123, v121, v181, v123 op_sel:[1,1,0] op_sel_hi:[0,1,1] neg_lo:[1,0,0]
    v_pk_fma_f16 v125, v121, v182, v125 op_sel:[1,1,0] op_sel_hi:[0,1,1] neg_lo:[1,0,0]
    v_pk_fma_f16 v126, v122, v182, v126 op_sel:[1,1,0] op_sel_hi:[0,1,1] neg_lo:[1,0,0]
    v_pk_fma_f16 v103, v100, v99, v103 op_sel:[1,1,0] op_sel_hi:[0,1,1] neg_lo:[1,0,0]
    v_pk_fma_f16 v111, v108, v107, v111 op_sel:[1,1,0] op_sel_hi:[0,1,1] neg_lo:[1,0,0]
    v_pk_fma_f16 v128, v120, v138, v128 op_sel:[1,1,0] op_sel_hi:[0,1,1] neg_lo:[1,0,0]
    v_pk_fma_f16 v129, v121, v138, v129 op_sel:[1,1,0] op_sel_hi:[0,1,1] neg_lo:[1,0,0]
    v_pk_fma_f16 v130, v122, v138, v130 op_sel:[1,1,0] op_sel_hi:[0,1,1] neg_lo:[1,0,0]
    v_pk_fma_f16 v132, v124, v138, v132 op_sel:[1,1,0] op_sel_hi:[0,1,1] neg_lo:[1,0,0]
    v_pk_fma_f16 v113, v112, v105, v113 op_sel:[1,1,0] op_sel_hi:[0,1,1] neg_lo:[1,0,0]
    v_pk_fma_f16 v114, v112, v106, v114 op_sel:[1,1,0] op_sel_hi:[0,1,1] neg_lo:[1,0,0]
    v_pk_fma_f16 v115, v112, v107, v115 op_sel:[1,1,0] op_sel_hi:[0,1,1] neg_lo:[1,0,0]
    v_pk_fma_f16 v116, v112, v108, v116 op_sel:[1,1,0] op_sel_hi:[0,1,1] neg_lo:[1,0,0]
    v_pk_fma_f16 v117, v112, v109, v117 op_sel:[1,1,0] op_sel_hi:[0,1,1] neg_lo:[1,0,0]
    v_pk_fma_f16 v118, v112, v110, v118 op_sel:[1,1,0] op_sel_hi:[0,1,1] neg_lo:[1,0,0]
    ds_write_b32 v11, v123 offset:5440
    ds_write_b32 v11, v125 offset:7072
    ds_write_b32 v11, v126 offset:7616
    ds_write_b32 v11, v111 offset:13056
    ds_write_b32 v11, v128 offset:8704
    ds_write_b32 v11, v129 offset:8976
    ds_write_b32 v11, v130 offset:9248
    ds_write_b32 v11, v132 offset:9792
    ds_write_b32 v11, v113 offset:13600
    ds_write_b32 v11, v114 offset:13872
    ds_write_b32 v11, v115 offset:14144
    ds_write_b32 v11, v116 offset:14416
    ds_write_b32 v11, v117 offset:14688
    ds_write_b32 v11, v118 offset:14960
    v_pk_mul_f16 v127, v123, v182 op_sel:[0,0] op_sel_hi:[1,0]
    v_pk_mul_f16 v119, v112, v111 op_sel:[0,0] op_sel_hi:[1,0]
    v_pk_mul_f16 v131, v123, v138 op_sel:[0,0] op_sel_hi:[1,0]
    v_pk_mul_f16 v133, v125, v138 op_sel:[0,0] op_sel_hi:[1,0]
    v_pk_mul_f16 v134, v126, v138 op_sel:[0,0] op_sel_hi:[1,0]
    v_pk_fma_f16 v127, v123, v182, v127 op_sel:[1,1,0] op_sel_hi:[0,1,1] neg_lo:[1,0,0]
    v_pk_fma_f16 v119, v112, v111, v119 op_sel:[1,1,0] op_sel_hi:[0,1,1] neg_lo:[1,0,0]
    v_pk_fma_f16 v131, v123, v138, v131 op_sel:[1,1,0] op_sel_hi:[0,1,1] neg_lo:[1,0,0]
    v_pk_fma_f16 v133, v125, v138, v133 op_sel:[1,1,0] op_sel_hi:[0,1,1] neg_lo:[1,0,0]
    v_pk_fma_f16 v134, v126, v138, v134 op_sel:[1,1,0] op_sel_hi:[0,1,1] neg_lo:[1,0,0]
    ds_write_b32 v11, v127 offset:8160
    ds_write_b32 v11, v119 offset:15232
    ds_write_b32 v11, v131 offset:9520
    ds_write_b32 v11, v133 offset:10064
    ds_write_b32 v11, v134 offset:10336
    v_pk_mul_f16 v140, v120, v97 op_sel:[0,0] op_sel_hi:[1,0]
    v_pk_mul_f16 v141, v120, v98 op_sel:[0,0] op_sel_hi:[1,0]
    v_pk_mul_f16 v142, v120, v99 op_sel:[0,0] op_sel_hi:[1,0]
    v_pk_mul_f16 v143, v120, v100 op_sel:[0,0] op_sel_hi:[1,0]
    v_pk_mul_f16 v144, v120, v101 op_sel:[0,0] op_sel_hi:[1,0]
    v_pk_mul_f16 v145, v120, v102 op_sel:[0,0] op_sel_hi:[1,0]
    v_pk_mul_f16 v146, v120, v103 op_sel:[0,0] op_sel_hi:[1,0]
    v_pk_mul_f16 v147, v121, v97 op_sel:[0,0] op_sel_hi:[1,0]
    v_pk_mul_f16 v148, v121, v98 op_sel:[0,0] op_sel_hi:[1,0]
    v_pk_mul_f16 v149, v121, v99 op_sel:[0,0] op_sel_hi:[1,0]
    v_pk_mul_f16 v150, v121, v100 op_sel:[0,0] op_sel_hi:[1,0]
    v_pk_mul_f16 v151, v121, v101 op_sel:[0,0] op_sel_hi:[1,0]
    v_pk_mul_f16 v152, v121, v102 op_sel:[0,0] op_sel_hi:[1,0]
    v_pk_fma_f16 v140, v120, v97, v140 op_sel:[1,1,0] op_sel_hi:[0,1,1] neg_lo:[1,0,0]
    v_pk_fma_f16 v141, v120, v98, v141 op_sel:[1,1,0] op_sel_hi:[0,1,1] neg_lo:[1,0,0]
    v_pk_fma_f16 v142, v120, v99, v142 op_sel:[1,1,0] op_sel_hi:[0,1,1] neg_lo:[1,0,0]
    v_pk_fma_f16 v143, v120, v100, v143 op_sel:[1,1,0] op_sel_hi:[0,1,1] neg_lo:[1,0,0]
    v_pk_fma_f16 v144, v120, v101, v144 op_sel:[1,1,0] op_sel_hi:[0,1,1] neg_lo:[1,0,0]
    v_pk_fma_f16 v145, v120, v102, v145 op_sel:[1,1,0] op_sel_hi:[0,1,1] neg_lo:[1,0,0]
    v_pk_fma_f16 v146, v120, v103, v146 op_sel:[1,1,0] op_sel_hi:[0,1,1] neg_lo:[1,0,0]
    v_pk_fma_f16 v147, v121, v97, v147 op_sel:[1,1,0] op_sel_hi:[0,1,1] neg_lo:[1,0,0]
    v_pk_fma_f16 v148, v121, v98, v148 op_sel:[1,1,0] op_sel_hi:[0,1,1] neg_lo:[1,0,0]
    v_pk_fma_f16 v149, v121, v99, v149 op_sel:[1,1,0] op_sel_hi:[0,1,1] neg_lo:[1,0,0]
    v_pk_fma_f16 v150, v121, v100, v150 op_sel:[1,1,0] op_sel_hi:[0,1,1] neg_lo:[1,0,0]
    v_pk_fma_f16 v151, v121, v101, v151 op_sel:[1,1,0] op_sel_hi:[0,1,1] neg_lo:[1,0,0]
    v_pk_fma_f16 v152, v121, v102, v152 op_sel:[1,1,0] op_sel_hi:[0,1,1] neg_lo:[1,0,0]
    ds_write_b32 v11, v140 offset:272
    ds_write_b32 v11, v141 offset:544
    ds_write_b32 v11, v142 offset:816
    ds_write_b32 v11, v143 offset:1088
    ds_write_b32 v11, v144 offset:1360
    ds_write_b32 v11, v145 offset:1632
    ds_write_b32 v11, v146 offset:1904
    ds_write_b32 v11, v147 offset:2448
    ds_write_b32 v11, v148 offset:2720
    ds_write_b32 v11, v149 offset:2992
    ds_write_b32 v11, v150 offset:3264
    ds_write_b32 v11, v151 offset:3536
    ds_write_b32 v11, v152 offset:3808
    v_pk_mul_f16 v153, v121, v103 op_sel:[0,0] op_sel_hi:[1,0]
    v_pk_mul_f16 v154, v122, v98 op_sel:[0,0] op_sel_hi:[1,0]
    v_pk_mul_f16 v155, v122, v100 op_sel:[0,0] op_sel_hi:[1,0]
    v_pk_mul_f16 v156, v122, v102 op_sel:[0,0] op_sel_hi:[1,0]
    v_pk_mul_f16 v157, v123, v98 op_sel:[0,0] op_sel_hi:[1,0]
    v_pk_mul_f16 v158, v123, v100 op_sel:[0,0] op_sel_hi:[1,0]
    v_pk_mul_f16 v159, v123, v102 op_sel:[0,0] op_sel_hi:[1,0]
    v_pk_mul_f16 v160, v124, v100 op_sel:[0,0] op_sel_hi:[1,0]
    v_pk_mul_f16 v161, v125, v100 op_sel:[0,0] op_sel_hi:[1,0]
    v_pk_mul_f16 v162, v126, v100 op_sel:[0,0] op_sel_hi:[1,0]
    v_pk_mul_f16 v163, v127, v100 op_sel:[0,0] op_sel_hi:[1,0]
    v_pk_mul_f16 v164, v128, v138 op_sel:[0,0] op_sel_hi:[1,0]
    v_pk_mul_f16 v165, v127, v138 op_sel:[0,0] op_sel_hi:[1,0]
    v_pk_fma_f16 v153, v121, v103, v153 op_sel:[1,1,0] op_sel_hi:[0,1,1] neg_lo:[1,0,0]
    v_pk_fma_f16 v154, v122, v98, v154 op_sel:[1,1,0] op_sel_hi:[0,1,1] neg_lo:[1,0,0]
    v_pk_fma_f16 v155, v122, v100, v155 op_sel:[1,1,0] op_sel_hi:[0,1,1] neg_lo:[1,0,0]
    v_pk_fma_f16 v156, v122, v102, v156 op_sel:[1,1,0] op_sel_hi:[0,1,1] neg_lo:[1,0,0]
    v_pk_fma_f16 v157, v123, v98, v157 op_sel:[1,1,0] op_sel_hi:[0,1,1] neg_lo:[1,0,0]
    v_pk_fma_f16 v158, v123, v100, v158 op_sel:[1,1,0] op_sel_hi:[0,1,1] neg_lo:[1,0,0]
    v_pk_fma_f16 v159, v123, v102, v159 op_sel:[1,1,0] op_sel_hi:[0,1,1] neg_lo:[1,0,0]
    v_pk_fma_f16 v160, v124, v100, v160 op_sel:[1,1,0] op_sel_hi:[0,1,1] neg_lo:[1,0,0]
    v_pk_fma_f16 v161, v125, v100, v161 op_sel:[1,1,0] op_sel_hi:[0,1,1] neg_lo:[1,0,0]
    v_pk_fma_f16 v162, v126, v100, v162 op_sel:[1,1,0] op_sel_hi:[0,1,1] neg_lo:[1,0,0]
    v_pk_fma_f16 v163, v127, v100, v163 op_sel:[1,1,0] op_sel_hi:[0,1,1] neg_lo:[1,0,0]
    v_pk_fma_f16 v164, v128, v138, v164 op_sel:[1,1,0] op_sel_hi:[0,1,1] neg_lo:[1,0,0]
    v_pk_fma_f16 v165, v127, v138, v165 op_sel:[1,1,0] op_sel_hi:[0,1,1] neg_lo:[1,0,0]
    ds_write_b32 v11, v153 offset:4080
    ds_write_b32 v11, v154 offset:4624
    ds_write_b32 v11, v155 offset:4896
    ds_write_b32 v11, v156 offset:5168
    ds_write_b32 v11, v157 offset:5712
    ds_write_b32 v11, v158 offset:5984
    ds_write_b32 v11, v159 offset:6256
    ds_write_b32 v11, v160 offset:6800
    ds_write_b32 v11, v161 offset:7344
    ds_write_b32 v11, v162 offset:7888
    ds_write_b32 v11, v163 offset:8432
    ds_write_b32 v11, v164 offset:10880
    ds_write_b32 v11, v165 offset:10608
    v_mul_u32_u24 v12, 272, v25
    v_lshl_add_u32 v12, v26, 4, v12
    v_add_u32 v12, s48, v12
    ds_read_b128 v[32:35], v12 offset:11152
    ds_read_b128 v[36:39], v12 offset:0
    ds_read_b128 v[40:43], v12 offset:4352
    ds_read_b128 v[44:47], v12 offset:8704
    ds_read_b128 v[48:51], v12 offset:11216
    ds_read_b128 v[52:55], v12 offset:64
    ds_read_b128 v[56:59], v12 offset:4416
    ds_read_b128 v[60:63], v12 offset:8768
    ds_read_b128 v[64:67], v12 offset:11280
    ds_read_b128 v[68:71], v12 offset:128
    ds_read_b128 v[72:75], v12 offset:4480
    ds_read_b128 v[76:79], v12 offset:8832
    ds_read_b128 v[80:83], v12 offset:11344
    ds_read_b128 v[84:87], v12 offset:192
    ds_read_b128 v[88:91], v12 offset:4544
    s_waitcnt lgkmcnt(14)
    ds_read_b128 v[92:95], v12 offset:8896
    v_lshlrev_b32 v13, 4, v1
    v_add_u32 v15, s48, v13
    s_lshl_b32 s48, s30, 10
    s_add_u32 s48, s48, s12
    v_add_u32 v13, s48, v13
    v_mov_b32 v14, 62016
    v_lshl_add_u32 v14, v25, 4, v14
    v_add_u32 v14, s12, v14
    s_waitcnt lgkmcnt(14)
    v_mfma_f32_16x16x32_f16 v[160:163], v[36:39], v[32:35], 0
    s_waitcnt lgkmcnt(13)
    v_mfma_f32_16x16x32_f16 v[164:167], v[40:43], v[32:35], 0
    s_waitcnt lgkmcnt(12)
    v_mfma_f32_16x16x32_f16 v[168:171], v[44:47], v[32:35], 0
    s_waitcnt lgkmcnt(10)
    v_mfma_f32_16x16x32_f16 v[160:163], v[52:55], v[48:51], v[160:163]
    s_waitcnt lgkmcnt(9)
    v_mfma_f32_16x16x32_f16 v[164:167], v[56:59], v[48:51], v[164:167]
    s_waitcnt lgkmcnt(8)
    v_mfma_f32_16x16x32_f16 v[168:171], v[60:63], v[48:51], v[168:171]
    s_waitcnt lgkmcnt(6)
    v_mfma_f32_16x16x32_f16 v[160:163], v[68:71], v[64:67], v[160:163]
    s_waitcnt lgkmcnt(5)
    v_mfma_f32_16x16x32_f16 v[164:167], v[72:75], v[64:67], v[164:167]
    s_waitcnt lgkmcnt(4)
    v_mfma_f32_16x16x32_f16 v[168:171], v[76:79], v[64:67], v[168:171]
    s_waitcnt lgkmcnt(2)
    v_mfma_f32_16x16x32_f16 v[160:163], v[84:87], v[80:83], v[160:163]
    s_waitcnt lgkmcnt(1)
    v_mfma_f32_16x16x32_f16 v[164:167], v[88:91], v[80:83], v[164:167]
    s_waitcnt lgkmcnt(0)
    v_mfma_f32_16x16x32_f16 v[168:171], v[92:95], v[80:83], v[168:171]
    s_nop 3
    ds_write_b128 v15, v[160:163] offset:0
    s_nop 0
    ds_write_b128 v15, v[164:167] offset:1024
    s_nop 0
    ds_write_b128 v15, v[168:171] offset:2048
    s_waitcnt lgkmcnt(0)
    s_barrier
    s_cmp_eq_u32 s30, 3
    s_cbranch_scc1 K1A_SKIPM
    ds_read_b128 v[160:163], v13 offset:0
    ds_read_b128 v[164:167], v13 offset:15504
    ds_read_b128 v[168:171], v13 offset:31008
    ds_read_b128 v[172:175], v13 offset:46512
    s_waitcnt lgkmcnt(0)
    v_add_f32 v160, v160, v164
    v_add_f32 v161, v161, v165
    v_add_f32 v162, v162, v166
    v_add_f32 v163, v163, v167
    v_add_f32 v168, v168, v172
    v_add_f32 v169, v169, v173
    v_add_f32 v170, v170, v174
    v_add_f32 v171, v171, v175
    v_add_f32 v160, v160, v168
    v_add_f32 v161, v161, v169
    v_add_f32 v162, v162, v170
    v_add_f32 v163, v163, v171
    v_mul_f32 v160, 0x3d000000, v160
    v_mul_f32 v161, 0x3d000000, v161
    v_mul_f32 v162, 0x3d000000, v162
    v_mul_f32 v163, 0x3d000000, v163
    v_cvt_pk_bf16_f32 v164, v160, v161
    v_cvt_pk_bf16_f32 v165, v162, v163
    s_cmp_eq_u32 s30, 1
    s_cbranch_scc1 K1A_M1
    s_cmp_eq_u32 s30, 2
    s_cbranch_scc1 K1A_M2
    v_lshrrev_b32 v12, 1, v26
    v_lshl_add_u32 v14, v12, 8, v14
    v_and_b32 v12, 1, v26
    v_lshl_add_u32 v14, v12, 3, v14
    ds_write_b64 v14, v[164:165]
    s_branch K1A_SKIPM
K1A_M1:
    v_lshl_add_u32 v12, v26, 8, v14
    v_lshl_add_u32 v13, v26, 9, v14
    s_mov_b32 exec_hi, 0
    ds_write_b16 v12, v164 offset:512
    ds_write_b16_d16_hi v12, v164 offset:516
    ds_write_b16 v12, v165 offset:520
    ds_write_b16_d16_hi v12, v165 offset:524
    s_mov_b32 exec_hi, -1
    s_mov_b32 exec_lo, 0
    ds_write_b16 v13, v164
    ds_write_b16_d16_hi v13, v164 offset:8
    ds_write_b16 v13, v165 offset:256
    ds_write_b16_d16_hi v13, v165 offset:264
    s_mov_b64 exec, -1
    s_branch K1A_SKIPM
K1A_M2:
    v_lshl_add_u32 v12, v26, 10, v14
    s_mov_b32 exec_hi, 0
    ds_write_b16 v12, v164 offset:2048
    ds_write_b16_d16_hi v12, v164 offset:2304
    ds_write_b16 v12, v165 offset:2560
    ds_write_b16_d16_hi v12, v165 offset:2816
    s_mov_b32 exec_hi, 1
    s_mov_b32 exec_lo, 0
    ds_write_b16 v12, v164 offset:2046
    s_mov_b64 exec, -1
K1A_SKIPM:
    s_waitcnt lgkmcnt(0)
    s_barrier
    s_cmp_lg_u32 s15, 1
    s_cbranch_scc1 K1A_NOWOF
    s_cmp_ge_u32 s29, 28
    s_cbranch_scc1 K1A_NOWOF
    v_lshrrev_b32 v225, 2, v1
    v_mul_u32_u24 v225, 896, v225
    v_and_b32 v226, 3, v1
    v_lshl_add_u32 v225, v226, 4, v225
    s_lshr_b32 s48, s30, 1
    s_lshl_b32 s48, s48, 6
    s_and_b32 s49, s30, 1
    s_lshl_b32 s49, s49, 3
    s_add_u32 s48, s48, s49
    s_mul_i32 s49, s31, 384
    s_add_u32 s48, s48, s49
    s_add_u32 s48, s48, 132352
    v_add_u32 v225, s48, v225
    ds_read_b64_tr_b16 v[228:229], v225 offset:0
    ds_read_b64_tr_b16 v[230:231], v225 offset:14336
    ds_read_b64_tr_b16 v[232:233], v225 offset:128
    ds_read_b64_tr_b16 v[234:235], v225 offset:14464
    ds_read_b64_tr_b16 v[236:237], v225 offset:256
    ds_read_b64_tr_b16 v[238:239], v225 offset:14592
    ds_read_b64_tr_b16 v[240:241], v225 offset:384
    ds_read_b64_tr_b16 v[242:243], v225 offset:14720
    s_mul_i32 s48, s30, 28672
    s_lshl_b32 s49, s29, 10
    s_add_u32 s48, s48, s49
    s_mul_i32 s49, s31, 344064
    s_add_u32 s48, s48, s49
    s_add_u32 s49, s48, 16777216
    s_waitcnt lgkmcnt(6)
    buffer_store_dwordx4 v[228:231], v3, s[16:19], s49 offen sc1
    s_add_u32 s49, s48, 16891904
    s_waitcnt lgkmcnt(4)
    buffer_store_dwordx4 v[232:235], v3, s[16:19], s49 offen sc1
    s_add_u32 s49, s48, 17006592
    s_waitcnt lgkmcnt(2)
    buffer_store_dwordx4 v[236:239], v3, s[16:19], s49 offen sc1
    s_add_u32 s49, s48, 17121280
    s_waitcnt lgkmcnt(0)
    buffer_store_dwordx4 v[240:243], v3, s[16:19], s49 offen sc1
    s_branch K1A_W2
K1A_NOWOF:
    s_waitcnt vmcnt(0)
K1A_W2:
    ds_read_b128 v[32:35], v24
    s_lshl_b32 s48, s13, 12
    s_add_u32 s48, s48, 20971520
    s_add_u32 s13, s13, 2
    s_add_u32 s15, s15, 1
    s_cmp_lt_u32 s15, 3
    s_waitcnt lgkmcnt(0)
    buffer_store_dwordx4 v[32:35], v4, s[16:19], s48 offen sc1
    s_cbranch_scc1 K1A_LOOP
K1_END:
    s_endpgm
.globl k2_kernel
.p2align 8
.type k2_kernel,@function
k2_kernel:
    s_cmp_ge_u32 s2, 512
    s_cbranch_scc1 K2_END
    v_and_b32 v1, 63, v0
    v_lshrrev_b32 v2, 6, v0
    s_nop 0
    v_readfirstlane_b32 s28, v2
    s_xor_b32 s2, s2, 256
    s_cmp_ge_u32 s2, 256
    s_cbranch_scc1 K2_CONV
    s_load_dwordx2 s[8:9], s[0:1], 72
    s_load_dwordx2 s[12:13], s[0:1], 112
    s_load_dwordx2 s[16:17], s[0:1], 80
    s_load_dwordx2 s[20:21], s[0:1], 0
    s_load_dwordx2 s[24:25], s[0:1], 96
    s_mov_b32 s10, 8388608
    s_mov_b32 s11, 0x00020000
    s_mov_b32 s14, 268435456
    s_mov_b32 s15, 0x00020000
    s_mov_b32 s18, 4096
    s_mov_b32 s19, 0x00020000
    s_mov_b32 s22, 1835008
    s_mov_b32 s23, 0x00020000
    s_mov_b32 s26, 1835008
    s_mov_b32 s27, 0x00020000
    s_and_b32 s48, s2, 7
    s_lshr_b32 s49, s2, 3
    s_lshr_b32 s29, s48, 1
    s_lshl_b32 s29, s29, 3
    s_and_b32 s50, s49, 7
    s_add_u32 s29, s29, s50
    s_and_b32 s30, s48, 1
    s_lshl_b32 s30, s30, 2
    s_lshr_b32 s50, s49, 3
    s_add_u32 s30, s30, s50
    v_lshrrev_b32 v8, 3, v1
    v_and_b32 v9, 7, v1
    v_lshrrev_b32 v10, 4, v1
    v_xor_b32 v9, v9, v10
    v_lshlrev_b32 v8, 12, v8
    v_lshl_add_u32 v2, v9, 4, v8
    v_xor_b32 v3, 64, v2
    s_lshl_b32 s48, s29, 18
    s_lshl_b32 s49, s28, 10
    s_add_u32 s48, s48, s49
    s_lshl_b32 s49, s28, 1
    s_xor_b32 s50, s49, 0
    s_lshl_b32 s50, s50, 15
    s_add_u32 s32, s48, s50
    s_xor_b32 s50, s49, 1
    s_lshl_b32 s50, s50, 15
    s_add_u32 s33, s48, s50
    s_xor_b32 s50, s49, 2
    s_lshl_b32 s50, s50, 15
    s_add_u32 s34, s48, s50
    s_xor_b32 s50, s49, 3
    s_lshl_b32 s50, s50, 15
    s_add_u32 s35, s48, s50
    s_xor_b32 s50, s49, 4
    s_lshl_b32 s50, s50, 15
    s_add_u32 s36, s48, s50
    s_xor_b32 s50, s49, 5
    s_lshl_b32 s50, s50, 15
    s_add_u32 s37, s48, s50
    s_xor_b32 s50, s49, 6
    s_lshl_b32 s50, s50, 15
    s_add_u32 s38, s48, s50
    s_xor_b32 s50, s49, 7
    s_lshl_b32 s50, s50, 15
    s_add_u32 s39, s48, s50
    s_lshl_b32 s31, s28, 14
    v_lshlrev_b32 v6, 4, v1
    v_add_u32 v7, 4096, v6
    s_lshl_b32 s40, s30, 6
    s_lshl_b32 s49, s28, 4
    s_add_u32 s40, s40, s49
    s_mul_i32 s40, s40, 7168
    s_and_b32 s44, s30, 1
    s_lshl_b32 s45, s44, 10
    v_add_u32 v14, s45, v6
    v_add_u32 v15, 4096, v14
    s_cmp_eq_u32 s44, 0
    s_cselect_b32 s45, 6144, 0
    v_add_u32 v244, s45, v6
    s_waitcnt lgkmcnt(0)
    s_add_u32 m0, s31, 0
    s_nop 0
    buffer_load_dwordx4 v2, s[8:11], s32 offen lds
    s_add_u32 m0, s31, 1024
    s_nop 0
    buffer_load_dwordx4 v3, s[8:11], s33 offen lds
    s_add_u32 m0, s31, 2048
    s_nop 0
    buffer_load_dwordx4 v2, s[8:11], s34 offen lds
    s_add_u32 m0, s31, 3072
    s_nop 0
    buffer_load_dwordx4 v3, s[8:11], s35 offen lds
    s_add_u32 m0, s31, 4096
    s_nop 0
    buffer_load_dwordx4 v2, s[8:11], s36 offen lds
    s_add_u32 m0, s31, 5120
    s_nop 0
    buffer_load_dwordx4 v3, s[8:11], s37 offen lds
    s_add_u32 m0, s31, 6144
    s_nop 0
    buffer_load_dwordx4 v2, s[8:11], s38 offen lds
    s_add_u32 m0, s31, 7168
    s_nop 0
    buffer_load_dwordx4 v3, s[8:11], s39 offen lds
    v_add_u32 v2, 128, v2
    v_add_u32 v3, 128, v3
    s_add_u32 s41, s40, 0
    buffer_load_dwordx4 v[128:131], v14, s[12:15], s41 offen offset:0
    buffer_load_dwordx4 v[132:135], v14, s[12:15], s41 offen offset:1024
    buffer_load_dwordx4 v[136:139], v14, s[12:15], s41 offen offset:2048
    buffer_load_dwordx4 v[140:143], v14, s[12:15], s41 offen offset:3072
    buffer_load_dwordx4 v[144:147], v15, s[12:15], s41 offen offset:0
    buffer_load_dwordx4 v[148:151], v15, s[12:15], s41 offen offset:1024
    buffer_load_dwordx4 v[152:155], v244, s[12:15], s41 offen
    s_add_u32 s41, s40, 7168
    buffer_load_dwordx4 v[156:159], v14, s[12:15], s41 offen offset:0
    buffer_load_dwordx4 v[160:163], v14, s[12:15], s41 offen offset:1024
    buffer_load_dwordx4 v[164:167], v14, s[12:15], s41 offen offset:2048
    buffer_load_dwordx4 v[168:171], v14, s[12:15], s41 offen offset:3072
    buffer_load_dwordx4 v[172:175], v15, s[12:15], s41 offen offset:0
    buffer_load_dwordx4 v[176:179], v15, s[12:15], s41 offen offset:1024
    buffer_load_dwordx4 v[180:183], v244, s[12:15], s41 offen
    s_add_u32 m0, s31, 8192
    s_nop 0
    buffer_load_dwordx4 v2, s[8:11], s32 offen lds
    s_add_u32 m0, s31, 9216
    s_nop 0
    buffer_load_dwordx4 v3, s[8:11], s33 offen lds
    s_add_u32 m0, s31, 10240
    s_nop 0
    buffer_load_dwordx4 v2, s[8:11], s34 offen lds
    s_add_u32 m0, s31, 11264
    s_nop 0
    buffer_load_dwordx4 v3, s[8:11], s35 offen lds
    s_add_u32 m0, s31, 12288
    s_nop 0
    buffer_load_dwordx4 v2, s[8:11], s36 offen lds
    s_add_u32 m0, s31, 13312
    s_nop 0
    buffer_load_dwordx4 v3, s[8:11], s37 offen lds
    s_add_u32 m0, s31, 14336
    s_nop 0
    buffer_load_dwordx4 v2, s[8:11], s38 offen lds
    s_add_u32 m0, s31, 15360
    s_nop 0
    buffer_load_dwordx4 v3, s[8:11], s39 offen lds
    v_add_u32 v2, 128, v2
    v_add_u32 v3, 128, v3
    s_add_u32 s41, s40, 14336
    buffer_load_dwordx4 v[184:187], v14, s[12:15], s41 offen offset:0
    buffer_load_dwordx4 v[188:191], v14, s[12:15], s41 offen offset:1024
    buffer_load_dwordx4 v[192:195], v14, s[12:15], s41 offen offset:2048
    buffer_load_dwordx4 v[196:199], v14, s[12:15], s41 offen offset:3072
    buffer_load_dwordx4 v[200:203], v15, s[12:15], s41 offen offset:0
    buffer_load_dwordx4 v[204:207], v15, s[12:15], s41 offen offset:1024
    buffer_load_dwordx4 v[208:211], v244, s[12:15], s41 offen
    v_and_b32 v8, 15, v1
    v_bfe_u32 v9, v1, 1, 3
    v_xor_b32 v9, v9, v10
    v_lshlrev_b32 v8, 7, v8
    v_lshl_add_u32 v4, v9, 4, v8
    v_add_u32 v4, s31, v4
    v_xor_b32 v5, 64, v4
    s_lshl_b32 s48, s29, 2
    s_add_u32 s48, s48, s28
    s_lshl_b32 s57, s48, 5
    s_mul_i32 s48, s48, 28672
    s_add_u32 s48, s48, 4194304
    s_mul_i32 s49, s30, 7
    s_add_u32 s42, s49, s44
    s_lshl_b32 s42, s42, 9
    s_add_u32 s50, s42, s48
    s_add_u32 s51, s50, 1024
    s_add_u32 s52, s50, 2048
    s_mul_i32 s42, s44, 4088
    s_add_u32 s53, s50, 3072
    s_sub_u32 s53, s53, s42
    s_mul_i32 s42, s44, 504
    s_add_u32 s56, s53, s42
    s_lshl_b32 s48, s29, 2
    s_add_u32 s48, s48, s28
    s_mul_i32 s48, s48, 14336
    s_lshl_b32 s49, s30, 7
    s_add_u32 s54, s48, s49
    s_mul_i32 s48, s28, 7168
    s_min_u32 s49, s30, 6
    s_mul_i32 s49, s49, 114688
    s_add_u32 s49, s49, s48
    s_add_u32 s88, s49, 16777216
    s_add_u32 s89, s49, 16805888
    s_add_u32 s90, s49, 16834560
    s_add_u32 s91, s49, 16863232
    s_lshl_b32 s49, s29, 2
    s_xor_b32 s42, s28, 0
    s_add_u32 s42, s42, s49
    s_mul_i32 s42, s42, 28672
    s_add_u32 s42, s42, s48
    s_add_u32 s92, s42, 8388608
    s_xor_b32 s42, s28, 1
    s_add_u32 s42, s42, s49
    s_mul_i32 s42, s42, 28672
    s_add_u32 s42, s42, s48
    s_add_u32 s93, s42, 8388608
    s_xor_b32 s42, s28, 2
    s_add_u32 s42, s42, s49
    s_mul_i32 s42, s42, 28672
    s_add_u32 s42, s42, s48
    s_add_u32 s94, s42, 8388608
    s_xor_b32 s42, s28, 3
    s_add_u32 s42, s42, s49
    s_mul_i32 s42, s42, 28672
    s_add_u32 s42, s42, s48
    s_add_u32 s95, s42, 8388608
    v_add_u32 v11, 0x400000, v6
    v_and_b32 v12, 15, v1
    v_lshlrev_b32 v12, 1, v12
    s_bfe_u32 s42, s2, 0x50003
    s_lshl_b32 s42, s42, 2
    s_add_u32 s42, s42, s28
    s_waitcnt vmcnt(29)
    ds_read_b128 v[212:215], v4 offset:0
    ds_read_b128 v[216:219], v4 offset:2048
    ds_read_b128 v[220:223], v4 offset:4096
    ds_read_b128 v[224:227], v4 offset:6144
    s_waitcnt lgkmcnt(0)
    ds_read_b128 v[228:231], v5 offset:0
    ds_read_b128 v[232:235], v5 offset:2048
    ds_read_b128 v[236:239], v5 offset:4096
    ds_read_b128 v[240:243], v5 offset:6144
    s_add_u32 s41, s40, 21504
    s_setprio 1
    s_waitcnt vmcnt(28)
    v_mfma_f32_16x16x32_bf16 v[16:19], v[128:131], v[212:215], 0
    v_mfma_f32_16x16x32_bf16 v[20:23], v[128:131], v[216:219], 0
    v_mfma_f32_16x16x32_bf16 v[24:27], v[128:131], v[220:223], 0
    v_mfma_f32_16x16x32_bf16 v[28:31], v[128:131], v[224:227], 0
    buffer_load_dwordx4 v[128:131], v14, s[12:15], s41 offen offset:0
    s_waitcnt vmcnt(28)
    v_mfma_f32_16x16x32_bf16 v[32:35], v[132:135], v[212:215], 0
    v_mfma_f32_16x16x32_bf16 v[36:39], v[132:135], v[216:219], 0
    v_mfma_f32_16x16x32_bf16 v[40:43], v[132:135], v[220:223], 0
    v_mfma_f32_16x16x32_bf16 v[44:47], v[132:135], v[224:227], 0
    buffer_load_dwordx4 v[132:135], v14, s[12:15], s41 offen offset:1024
    s_waitcnt lgkmcnt(0)
    s_waitcnt vmcnt(28)
    v_mfma_f32_16x16x32_bf16 v[48:51], v[136:139], v[212:215], 0
    v_mfma_f32_16x16x32_bf16 v[52:55], v[136:139], v[216:219], 0
    v_mfma_f32_16x16x32_bf16 v[56:59], v[136:139], v[220:223], 0
    v_mfma_f32_16x16x32_bf16 v[60:63], v[136:139], v[224:227], 0
    buffer_load_dwordx4 v[136:139], v14, s[12:15], s41 offen offset:2048
    s_add_u32 m0, s31, 0
    s_nop 0
    buffer_load_dwordx4 v2, s[8:11], s32 offen lds
    s_add_u32 m0, s31, 1024
    s_nop 0
    buffer_load_dwordx4 v3, s[8:11], s33 offen lds
    s_waitcnt vmcnt(30)
    v_mfma_f32_16x16x32_bf16 v[64:67], v[140:143], v[212:215], 0
    v_mfma_f32_16x16x32_bf16 v[68:71], v[140:143], v[216:219], 0
    v_mfma_f32_16x16x32_bf16 v[72:75], v[140:143], v[220:223], 0
    v_mfma_f32_16x16x32_bf16 v[76:79], v[140:143], v[224:227], 0
    buffer_load_dwordx4 v[140:143], v14, s[12:15], s41 offen offset:3072
    s_add_u32 m0, s31, 2048
    s_nop 0
    buffer_load_dwordx4 v2, s[8:11], s34 offen lds
    s_add_u32 m0, s31, 3072
    s_nop 0
    buffer_load_dwordx4 v3, s[8:11], s35 offen lds
    s_waitcnt vmcnt(32)
    v_mfma_f32_16x16x32_bf16 v[80:83], v[144:147], v[212:215], 0
    v_mfma_f32_16x16x32_bf16 v[84:87], v[144:147], v[216:219], 0
    v_mfma_f32_16x16x32_bf16 v[88:91], v[144:147], v[220:223], 0
    v_mfma_f32_16x16x32_bf16 v[92:95], v[144:147], v[224:227], 0
    buffer_load_dwordx4 v[144:147], v15, s[12:15], s41 offen offset:0
    s_add_u32 m0, s31, 4096
    s_nop 0
    buffer_load_dwordx4 v2, s[8:11], s36 offen lds
    s_add_u32 m0, s31, 5120
    s_nop 0
    buffer_load_dwordx4 v3, s[8:11], s37 offen lds
    s_waitcnt vmcnt(34)
    v_mfma_f32_16x16x32_bf16 v[96:99], v[148:151], v[212:215], 0
    v_mfma_f32_16x16x32_bf16 v[100:103], v[148:151], v[216:219], 0
    v_mfma_f32_16x16x32_bf16 v[104:107], v[148:151], v[220:223], 0
    v_mfma_f32_16x16x32_bf16 v[108:111], v[148:151], v[224:227], 0
    buffer_load_dwordx4 v[148:151], v15, s[12:15], s41 offen offset:1024
    s_add_u32 m0, s31, 6144
    s_nop 0
    buffer_load_dwordx4 v2, s[8:11], s38 offen lds
    s_add_u32 m0, s31, 7168
    s_nop 0
    buffer_load_dwordx4 v3, s[8:11], s39 offen lds
    v_add_u32 v2, 128, v2
    v_add_u32 v3, 128, v3
    s_waitcnt vmcnt(36)
    v_mfma_f32_16x16x32_bf16 v[112:115], v[152:155], v[212:215], 0
    v_mfma_f32_16x16x32_bf16 v[116:119], v[152:155], v[216:219], 0
    v_mfma_f32_16x16x32_bf16 v[120:123], v[152:155], v[220:223], 0
    v_mfma_f32_16x16x32_bf16 v[124:127], v[152:155], v[224:227], 0
    buffer_load_dwordx4 v[152:155], v244, s[12:15], s41 offen
    s_waitcnt lgkmcnt(0)
    s_add_u32 s41, s40, 28672
    s_waitcnt vmcnt(36)
    v_mfma_f32_16x16x32_bf16 v[16:19], v[156:159], v[228:231], v[16:19]
    v_mfma_f32_16x16x32_bf16 v[20:23], v[156:159], v[232:235], v[20:23]
    v_mfma_f32_16x16x32_bf16 v[24:27], v[156:159], v[236:239], v[24:27]
    v_mfma_f32_16x16x32_bf16 v[28:31], v[156:159], v[240:243], v[28:31]
    buffer_load_dwordx4 v[156:159], v14, s[12:15], s41 offen offset:0
    s_waitcnt vmcnt(36)
    v_mfma_f32_16x16x32_bf16 v[32:35], v[160:163], v[228:231], v[32:35]
    v_mfma_f32_16x16x32_bf16 v[36:39], v[160:163], v[232:235], v[36:39]
    v_mfma_f32_16x16x32_bf16 v[40:43], v[160:163], v[236:239], v[40:43]
    v_mfma_f32_16x16x32_bf16 v[44:47], v[160:163], v[240:243], v[44:47]
    buffer_load_dwordx4 v[160:163], v14, s[12:15], s41 offen offset:1024
    s_waitcnt vmcnt(36)
    v_mfma_f32_16x16x32_bf16 v[48:51], v[164:167], v[228:231], v[48:51]
    v_mfma_f32_16x16x32_bf16 v[52:55], v[164:167], v[232:235], v[52:55]
    v_mfma_f32_16x16x32_bf16 v[56:59], v[164:167], v[236:239], v[56:59]
    v_mfma_f32_16x16x32_bf16 v[60:63], v[164:167], v[240:243], v[60:63]
    buffer_load_dwordx4 v[164:167], v14, s[12:15], s41 offen offset:2048
    s_waitcnt vmcnt(36)
    v_mfma_f32_16x16x32_bf16 v[64:67], v[168:171], v[228:231], v[64:67]
    v_mfma_f32_16x16x32_bf16 v[68:71], v[168:171], v[232:235], v[68:71]
    v_mfma_f32_16x16x32_bf16 v[72:75], v[168:171], v[236:239], v[72:75]
    v_mfma_f32_16x16x32_bf16 v[76:79], v[168:171], v[240:243], v[76:79]
    buffer_load_dwordx4 v[168:171], v14, s[12:15], s41 offen offset:3072
    s_waitcnt vmcnt(26)
    ds_read_b128 v[212:215], v4 offset:8192
    ds_read_b128 v[216:219], v4 offset:10240
    ds_read_b128 v[220:223], v4 offset:12288
    ds_read_b128 v[224:227], v4 offset:14336
    v_mfma_f32_16x16x32_bf16 v[80:83], v[172:175], v[228:231], v[80:83]
    v_mfma_f32_16x16x32_bf16 v[84:87], v[172:175], v[232:235], v[84:87]
    v_mfma_f32_16x16x32_bf16 v[88:91], v[172:175], v[236:239], v[88:91]
    v_mfma_f32_16x16x32_bf16 v[92:95], v[172:175], v[240:243], v[92:95]
    buffer_load_dwordx4 v[172:175], v15, s[12:15], s41 offen offset:0
    v_mfma_f32_16x16x32_bf16 v[96:99], v[176:179], v[228:231], v[96:99]
    v_mfma_f32_16x16x32_bf16 v[100:103], v[176:179], v[232:235], v[100:103]
    v_mfma_f32_16x16x32_bf16 v[104:107], v[176:179], v[236:239], v[104:107]
    v_mfma_f32_16x16x32_bf16 v[108:111], v[176:179], v[240:243], v[108:111]
    buffer_load_dwordx4 v[176:179], v15, s[12:15], s41 offen offset:1024
    v_mfma_f32_16x16x32_bf16 v[112:115], v[180:183], v[228:231], v[112:115]
    v_mfma_f32_16x16x32_bf16 v[116:119], v[180:183], v[232:235], v[116:119]
    v_mfma_f32_16x16x32_bf16 v[120:123], v[180:183], v[236:239], v[120:123]
    v_mfma_f32_16x16x32_bf16 v[124:127], v[180:183], v[240:243], v[124:127]
    buffer_load_dwordx4 v[180:183], v244, s[12:15], s41 offen
    s_waitcnt lgkmcnt(0)
    ds_read_b128 v[228:231], v5 offset:8192
    ds_read_b128 v[232:235], v5 offset:10240
    ds_read_b128 v[236:239], v5 offset:12288
    ds_read_b128 v[240:243], v5 offset:14336
    s_add_u32 s41, s40, 35840
    s_waitcnt vmcnt(28)
    v_mfma_f32_16x16x32_bf16 v[16:19], v[184:187], v[212:215], v[16:19]
    v_mfma_f32_16x16x32_bf16 v[20:23], v[184:187], v[216:219], v[20:23]
    v_mfma_f32_16x16x32_bf16 v[24:27], v[184:187], v[220:223], v[24:27]
    v_mfma_f32_16x16x32_bf16 v[28:31], v[184:187], v[224:227], v[28:31]
    buffer_load_dwordx4 v[184:187], v14, s[12:15], s41 offen offset:0
    s_waitcnt vmcnt(28)
    v_mfma_f32_16x16x32_bf16 v[32:35], v[188:191], v[212:215], v[32:35]
    v_mfma_f32_16x16x32_bf16 v[36:39], v[188:191], v[216:219], v[36:39]
    v_mfma_f32_16x16x32_bf16 v[40:43], v[188:191], v[220:223], v[40:43]
    v_mfma_f32_16x16x32_bf16 v[44:47], v[188:191], v[224:227], v[44:47]
    buffer_load_dwordx4 v[188:191], v14, s[12:15], s41 offen offset:1024
    s_waitcnt lgkmcnt(0)
    s_waitcnt vmcnt(28)
    v_mfma_f32_16x16x32_bf16 v[48:51], v[192:195], v[212:215], v[48:51]
    v_mfma_f32_16x16x32_bf16 v[52:55], v[192:195], v[216:219], v[52:55]
    v_mfma_f32_16x16x32_bf16 v[56:59], v[192:195], v[220:223], v[56:59]
    v_mfma_f32_16x16x32_bf16 v[60:63], v[192:195], v[224:227], v[60:63]
    buffer_load_dwordx4 v[192:195], v14, s[12:15], s41 offen offset:2048
    s_add_u32 m0, s31, 8192
    s_nop 0
    buffer_load_dwordx4 v2, s[8:11], s32 offen lds
    s_add_u32 m0, s31, 9216
    s_nop 0
    buffer_load_dwordx4 v3, s[8:11], s33 offen lds
    s_waitcnt vmcnt(30)
    v_mfma_f32_16x16x32_bf16 v[64:67], v[196:199], v[212:215], v[64:67]
    v_mfma_f32_16x16x32_bf16 v[68:71], v[196:199], v[216:219], v[68:71]
    v_mfma_f32_16x16x32_bf16 v[72:75], v[196:199], v[220:223], v[72:75]
    v_mfma_f32_16x16x32_bf16 v[76:79], v[196:199], v[224:227], v[76:79]
    buffer_load_dwordx4 v[196:199], v14, s[12:15], s41 offen offset:3072
    s_add_u32 m0, s31, 10240
    s_nop 0
    buffer_load_dwordx4 v2, s[8:11], s34 offen lds
    s_add_u32 m0, s31, 11264
    s_nop 0
    buffer_load_dwordx4 v3, s[8:11], s35 offen lds
    s_waitcnt vmcnt(32)
    v_mfma_f32_16x16x32_bf16 v[80:83], v[200:203], v[212:215], v[80:83]
    v_mfma_f32_16x16x32_bf16 v[84:87], v[200:203], v[216:219], v[84:87]
    v_mfma_f32_16x16x32_bf16 v[88:91], v[200:203], v[220:223], v[88:91]
    v_mfma_f32_16x16x32_bf16 v[92:95], v[200:203], v[224:227], v[92:95]
    buffer_load_dwordx4 v[200:203], v15, s[12:15], s41 offen offset:0
    s_add_u32 m0, s31, 12288
    s_nop 0
    buffer_load_dwordx4 v2, s[8:11], s36 offen lds
    s_add_u32 m0, s31, 13312
    s_nop 0
    buffer_load_dwordx4 v3, s[8:11], s37 offen lds
    s_waitcnt vmcnt(34)
    v_mfma_f32_16x16x32_bf16 v[96:99], v[204:207], v[212:215], v[96:99]
    v_mfma_f32_16x16x32_bf16 v[100:103], v[204:207], v[216:219], v[100:103]
    v_mfma_f32_16x16x32_bf16 v[104:107], v[204:207], v[220:223], v[104:107]
    v_mfma_f32_16x16x32_bf16 v[108:111], v[204:207], v[224:227], v[108:111]
    buffer_load_dwordx4 v[204:207], v15, s[12:15], s41 offen offset:1024
    s_add_u32 m0, s31, 14336
    s_nop 0
    buffer_load_dwordx4 v2, s[8:11], s38 offen lds
    s_add_u32 m0, s31, 15360
    s_nop 0
    buffer_load_dwordx4 v3, s[8:11], s39 offen lds
    v_add_u32 v2, 128, v2
    v_add_u32 v3, 128, v3
    s_waitcnt vmcnt(36)
    v_mfma_f32_16x16x32_bf16 v[112:115], v[208:211], v[212:215], v[112:115]
    v_mfma_f32_16x16x32_bf16 v[116:119], v[208:211], v[216:219], v[116:119]
    v_mfma_f32_16x16x32_bf16 v[120:123], v[208:211], v[220:223], v[120:123]
    v_mfma_f32_16x16x32_bf16 v[124:127], v[208:211], v[224:227], v[124:127]
    buffer_load_dwordx4 v[208:211], v244, s[12:15], s41 offen
    s_waitcnt lgkmcnt(0)
    s_add_u32 s41, s40, 43008
    s_waitcnt vmcnt(36)
    v_mfma_f32_16x16x32_bf16 v[16:19], v[128:131], v[228:231], v[16:19]
    v_mfma_f32_16x16x32_bf16 v[20:23], v[128:131], v[232:235], v[20:23]
    v_mfma_f32_16x16x32_bf16 v[24:27], v[128:131], v[236:239], v[24:27]
    v_mfma_f32_16x16x32_bf16 v[28:31], v[128:131], v[240:243], v[28:31]
    buffer_load_dwordx4 v[128:131], v14, s[12:15], s41 offen offset:0
    s_waitcnt vmcnt(36)
    v_mfma_f32_16x16x32_bf16 v[32:35], v[132:135], v[228:231], v[32:35]
    v_mfma_f32_16x16x32_bf16 v[36:39], v[132:135], v[232:235], v[36:39]
    v_mfma_f32_16x16x32_bf16 v[40:43], v[132:135], v[236:239], v[40:43]
    v_mfma_f32_16x16x32_bf16 v[44:47], v[132:135], v[240:243], v[44:47]
    buffer_load_dwordx4 v[132:135], v14, s[12:15], s41 offen offset:1024
    s_waitcnt vmcnt(36)
    v_mfma_f32_16x16x32_bf16 v[48:51], v[136:139], v[228:231], v[48:51]
    v_mfma_f32_16x16x32_bf16 v[52:55], v[136:139], v[232:235], v[52:55]
    v_mfma_f32_16x16x32_bf16 v[56:59], v[136:139], v[236:239], v[56:59]
    v_mfma_f32_16x16x32_bf16 v[60:63], v[136:139], v[240:243], v[60:63]
    buffer_load_dwordx4 v[136:139], v14, s[12:15], s41 offen offset:2048
    s_waitcnt vmcnt(34)
    v_mfma_f32_16x16x32_bf16 v[64:67], v[140:143], v[228:231], v[64:67]
    v_mfma_f32_16x16x32_bf16 v[68:71], v[140:143], v[232:235], v[68:71]
    v_mfma_f32_16x16x32_bf16 v[72:75], v[140:143], v[236:239], v[72:75]
    v_mfma_f32_16x16x32_bf16 v[76:79], v[140:143], v[240:243], v[76:79]
    buffer_load_dwordx4 v[140:143], v14, s[12:15], s41 offen offset:3072
    s_waitcnt vmcnt(27)
    ds_read_b128 v[212:215], v4 offset:0
    ds_read_b128 v[216:219], v4 offset:2048
    ds_read_b128 v[220:223], v4 offset:4096
    ds_read_b128 v[224:227], v4 offset:6144
    v_mfma_f32_16x16x32_bf16 v[80:83], v[144:147], v[228:231], v[80:83]
    v_mfma_f32_16x16x32_bf16 v[84:87], v[144:147], v[232:235], v[84:87]
    v_mfma_f32_16x16x32_bf16 v[88:91], v[144:147], v[236:239], v[88:91]
    v_mfma_f32_16x16x32_bf16 v[92:95], v[144:147], v[240:243], v[92:95]
    buffer_load_dwordx4 v[144:147], v15, s[12:15], s41 offen offset:0
    v_mfma_f32_16x16x32_bf16 v[96:99], v[148:151], v[228:231], v[96:99]
    v_mfma_f32_16x16x32_bf16 v[100:103], v[148:151], v[232:235], v[100:103]
    v_mfma_f32_16x16x32_bf16 v[104:107], v[148:151], v[236:239], v[104:107]
    v_mfma_f32_16x16x32_bf16 v[108:111], v[148:151], v[240:243], v[108:111]
    buffer_load_dwordx4 v[148:151], v15, s[12:15], s41 offen offset:1024
    s_waitcnt vmcnt(28)
    v_mfma_f32_16x16x32_bf16 v[112:115], v[152:155], v[228:231], v[112:115]
    v_mfma_f32_16x16x32_bf16 v[116:119], v[152:155], v[232:235], v[116:119]
    v_mfma_f32_16x16x32_bf16 v[120:123], v[152:155], v[236:239], v[120:123]
    v_mfma_f32_16x16x32_bf16 v[124:127], v[152:155], v[240:243], v[124:127]
    buffer_load_dwordx4 v[152:155], v244, s[12:15], s41 offen
    s_waitcnt lgkmcnt(0)
    ds_read_b128 v[228:231], v5 offset:0
    ds_read_b128 v[232:235], v5 offset:2048
    ds_read_b128 v[236:239], v5 offset:4096
    ds_read_b128 v[240:243], v5 offset:6144
    s_add_u32 s41, s40, 50176
    s_waitcnt vmcnt(28)
    v_mfma_f32_16x16x32_bf16 v[16:19], v[156:159], v[212:215], v[16:19]
    v_mfma_f32_16x16x32_bf16 v[20:23], v[156:159], v[216:219], v[20:23]
    v_mfma_f32_16x16x32_bf16 v[24:27], v[156:159], v[220:223], v[24:27]
    v_mfma_f32_16x16x32_bf16 v[28:31], v[156:159], v[224:227], v[28:31]
    buffer_load_dwordx4 v[156:159], v14, s[12:15], s41 offen offset:0
    s_waitcnt vmcnt(28)
    v_mfma_f32_16x16x32_bf16 v[32:35], v[160:163], v[212:215], v[32:35]
    v_mfma_f32_16x16x32_bf16 v[36:39], v[160:163], v[216:219], v[36:39]
    v_mfma_f32_16x16x32_bf16 v[40:43], v[160:163], v[220:223], v[40:43]
    v_mfma_f32_16x16x32_bf16 v[44:47], v[160:163], v[224:227], v[44:47]
    buffer_load_dwordx4 v[160:163], v14, s[12:15], s41 offen offset:1024
    s_waitcnt lgkmcnt(0)
    s_waitcnt vmcnt(28)
    v_mfma_f32_16x16x32_bf16 v[48:51], v[164:167], v[212:215], v[48:51]
    v_mfma_f32_16x16x32_bf16 v[52:55], v[164:167], v[216:219], v[52:55]
    v_mfma_f32_16x16x32_bf16 v[56:59], v[164:167], v[220:223], v[56:59]
    v_mfma_f32_16x16x32_bf16 v[60:63], v[164:167], v[224:227], v[60:63]
    buffer_load_dwordx4 v[164:167], v14, s[12:15], s41 offen offset:2048
    s_add_u32 m0, s31, 0
    s_nop 0
    buffer_load_dwordx4 v2, s[8:11], s32 offen lds
    s_add_u32 m0, s31, 1024
    s_nop 0
    buffer_load_dwordx4 v3, s[8:11], s33 offen lds
    s_waitcnt vmcnt(30)
    v_mfma_f32_16x16x32_bf16 v[64:67], v[168:171], v[212:215], v[64:67]
    v_mfma_f32_16x16x32_bf16 v[68:71], v[168:171], v[216:219], v[68:71]
    v_mfma_f32_16x16x32_bf16 v[72:75], v[168:171], v[220:223], v[72:75]
    v_mfma_f32_16x16x32_bf16 v[76:79], v[168:171], v[224:227], v[76:79]
    buffer_load_dwordx4 v[168:171], v14, s[12:15], s41 offen offset:3072
    s_add_u32 m0, s31, 2048
    s_nop 0
    buffer_load_dwordx4 v2, s[8:11], s34 offen lds
    s_add_u32 m0, s31, 3072
    s_nop 0
    buffer_load_dwordx4 v3, s[8:11], s35 offen lds
    s_waitcnt vmcnt(32)
    v_mfma_f32_16x16x32_bf16 v[80:83], v[172:175], v[212:215], v[80:83]
    v_mfma_f32_16x16x32_bf16 v[84:87], v[172:175], v[216:219], v[84:87]
    v_mfma_f32_16x16x32_bf16 v[88:91], v[172:175], v[220:223], v[88:91]
    v_mfma_f32_16x16x32_bf16 v[92:95], v[172:175], v[224:227], v[92:95]
    buffer_load_dwordx4 v[172:175], v15, s[12:15], s41 offen offset:0
    s_add_u32 m0, s31, 4096
    s_nop 0
    buffer_load_dwordx4 v2, s[8:11], s36 offen lds
    s_add_u32 m0, s31, 5120
    s_nop 0
    buffer_load_dwordx4 v3, s[8:11], s37 offen lds
    s_waitcnt vmcnt(34)
    v_mfma_f32_16x16x32_bf16 v[96:99], v[176:179], v[212:215], v[96:99]
    v_mfma_f32_16x16x32_bf16 v[100:103], v[176:179], v[216:219], v[100:103]
    v_mfma_f32_16x16x32_bf16 v[104:107], v[176:179], v[220:223], v[104:107]
    v_mfma_f32_16x16x32_bf16 v[108:111], v[176:179], v[224:227], v[108:111]
    buffer_load_dwordx4 v[176:179], v15, s[12:15], s41 offen offset:1024
    s_add_u32 m0, s31, 6144
    s_nop 0
    buffer_load_dwordx4 v2, s[8:11], s38 offen lds
    s_add_u32 m0, s31, 7168
    s_nop 0
    buffer_load_dwordx4 v3, s[8:11], s39 offen lds
    v_add_u32 v2, 128, v2
    v_add_u32 v3, 128, v3
    s_waitcnt vmcnt(36)
    v_mfma_f32_16x16x32_bf16 v[112:115], v[180:183], v[212:215], v[112:115]
    v_mfma_f32_16x16x32_bf16 v[116:119], v[180:183], v[216:219], v[116:119]
    v_mfma_f32_16x16x32_bf16 v[120:123], v[180:183], v[220:223], v[120:123]
    v_mfma_f32_16x16x32_bf16 v[124:127], v[180:183], v[224:227], v[124:127]
    buffer_load_dwordx4 v[180:183], v244, s[12:15], s41 offen
    s_waitcnt lgkmcnt(0)
    s_add_u32 s41, s40, 57344
    s_waitcnt vmcnt(36)
    v_mfma_f32_16x16x32_bf16 v[16:19], v[184:187], v[228:231], v[16:19]
    v_mfma_f32_16x16x32_bf16 v[20:23], v[184:187], v[232:235], v[20:23]
    v_mfma_f32_16x16x32_bf16 v[24:27], v[184:187], v[236:239], v[24:27]
    v_mfma_f32_16x16x32_bf16 v[28:31], v[184:187], v[240:243], v[28:31]
    buffer_load_dwordx4 v[184:187], v14, s[12:15], s41 offen offset:0
    s_waitcnt vmcnt(36)
    v_mfma_f32_16x16x32_bf16 v[32:35], v[188:191], v[228:231], v[32:35]
    v_mfma_f32_16x16x32_bf16 v[36:39], v[188:191], v[232:235], v[36:39]
    v_mfma_f32_16x16x32_bf16 v[40:43], v[188:191], v[236:239], v[40:43]
    v_mfma_f32_16x16x32_bf16 v[44:47], v[188:191], v[240:243], v[44:47]
    buffer_load_dwordx4 v[188:191], v14, s[12:15], s41 offen offset:1024
    s_waitcnt vmcnt(36)
    v_mfma_f32_16x16x32_bf16 v[48:51], v[192:195], v[228:231], v[48:51]
    v_mfma_f32_16x16x32_bf16 v[52:55], v[192:195], v[232:235], v[52:55]
    v_mfma_f32_16x16x32_bf16 v[56:59], v[192:195], v[236:239], v[56:59]
    v_mfma_f32_16x16x32_bf16 v[60:63], v[192:195], v[240:243], v[60:63]
    buffer_load_dwordx4 v[192:195], v14, s[12:15], s41 offen offset:2048
    s_waitcnt vmcnt(34)
    v_mfma_f32_16x16x32_bf16 v[64:67], v[196:199], v[228:231], v[64:67]
    v_mfma_f32_16x16x32_bf16 v[68:71], v[196:199], v[232:235], v[68:71]
    v_mfma_f32_16x16x32_bf16 v[72:75], v[196:199], v[236:239], v[72:75]
    v_mfma_f32_16x16x32_bf16 v[76:79], v[196:199], v[240:243], v[76:79]
    buffer_load_dwordx4 v[196:199], v14, s[12:15], s41 offen offset:3072
    s_waitcnt vmcnt(27)
    ds_read_b128 v[212:215], v4 offset:8192
    ds_read_b128 v[216:219], v4 offset:10240
    ds_read_b128 v[220:223], v4 offset:12288
    ds_read_b128 v[224:227], v4 offset:14336
    v_mfma_f32_16x16x32_bf16 v[80:83], v[200:203], v[228:231], v[80:83]
    v_mfma_f32_16x16x32_bf16 v[84:87], v[200:203], v[232:235], v[84:87]
    v_mfma_f32_16x16x32_bf16 v[88:91], v[200:203], v[236:239], v[88:91]
    v_mfma_f32_16x16x32_bf16 v[92:95], v[200:203], v[240:243], v[92:95]
    buffer_load_dwordx4 v[200:203], v15, s[12:15], s41 offen offset:0
    v_mfma_f32_16x16x32_bf16 v[96:99], v[204:207], v[228:231], v[96:99]
    v_mfma_f32_16x16x32_bf16 v[100:103], v[204:207], v[232:235], v[100:103]
    v_mfma_f32_16x16x32_bf16 v[104:107], v[204:207], v[236:239], v[104:107]
    v_mfma_f32_16x16x32_bf16 v[108:111], v[204:207], v[240:243], v[108:111]
    buffer_load_dwordx4 v[204:207], v15, s[12:15], s41 offen offset:1024
    s_waitcnt vmcnt(28)
    v_mfma_f32_16x16x32_bf16 v[112:115], v[208:211], v[228:231], v[112:115]
    v_mfma_f32_16x16x32_bf16 v[116:119], v[208:211], v[232:235], v[116:119]
    v_mfma_f32_16x16x32_bf16 v[120:123], v[208:211], v[236:239], v[120:123]
    v_mfma_f32_16x16x32_bf16 v[124:127], v[208:211], v[240:243], v[124:127]
    buffer_load_dwordx4 v[208:211], v244, s[12:15], s41 offen
    s_waitcnt lgkmcnt(0)
    ds_read_b128 v[228:231], v5 offset:8192
    ds_read_b128 v[232:235], v5 offset:10240
    ds_read_b128 v[236:239], v5 offset:12288
    ds_read_b128 v[240:243], v5 offset:14336
    s_add_u32 s41, s40, 64512
    s_waitcnt vmcnt(28)
    v_mfma_f32_16x16x32_bf16 v[16:19], v[128:131], v[212:215], v[16:19]
    v_mfma_f32_16x16x32_bf16 v[20:23], v[128:131], v[216:219], v[20:23]
    v_mfma_f32_16x16x32_bf16 v[24:27], v[128:131], v[220:223], v[24:27]
    v_mfma_f32_16x16x32_bf16 v[28:31], v[128:131], v[224:227], v[28:31]
    buffer_load_dwordx4 v[128:131], v14, s[12:15], s41 offen offset:0
    s_waitcnt vmcnt(28)
    v_mfma_f32_16x16x32_bf16 v[32:35], v[132:135], v[212:215], v[32:35]
    v_mfma_f32_16x16x32_bf16 v[36:39], v[132:135], v[216:219], v[36:39]
    v_mfma_f32_16x16x32_bf16 v[40:43], v[132:135], v[220:223], v[40:43]
    v_mfma_f32_16x16x32_bf16 v[44:47], v[132:135], v[224:227], v[44:47]
    buffer_load_dwordx4 v[132:135], v14, s[12:15], s41 offen offset:1024
    s_waitcnt lgkmcnt(0)
    s_waitcnt vmcnt(28)
    v_mfma_f32_16x16x32_bf16 v[48:51], v[136:139], v[212:215], v[48:51]
    v_mfma_f32_16x16x32_bf16 v[52:55], v[136:139], v[216:219], v[52:55]
    v_mfma_f32_16x16x32_bf16 v[56:59], v[136:139], v[220:223], v[56:59]
    v_mfma_f32_16x16x32_bf16 v[60:63], v[136:139], v[224:227], v[60:63]
    buffer_load_dwordx4 v[136:139], v14, s[12:15], s41 offen offset:2048
    s_add_u32 m0, s31, 8192
    s_nop 0
    buffer_load_dwordx4 v2, s[8:11], s32 offen lds
    s_add_u32 m0, s31, 9216
    s_nop 0
    buffer_load_dwordx4 v3, s[8:11], s33 offen lds
    s_waitcnt vmcnt(30)
    v_mfma_f32_16x16x32_bf16 v[64:67], v[140:143], v[212:215], v[64:67]
    v_mfma_f32_16x16x32_bf16 v[68:71], v[140:143], v[216:219], v[68:71]
    v_mfma_f32_16x16x32_bf16 v[72:75], v[140:143], v[220:223], v[72:75]
    v_mfma_f32_16x16x32_bf16 v[76:79], v[140:143], v[224:227], v[76:79]
    buffer_load_dwordx4 v[140:143], v14, s[12:15], s41 offen offset:3072
    s_add_u32 m0, s31, 10240
    s_nop 0
    buffer_load_dwordx4 v2, s[8:11], s34 offen lds
    s_add_u32 m0, s31, 11264
    s_nop 0
    buffer_load_dwordx4 v3, s[8:11], s35 offen lds
    s_waitcnt vmcnt(32)
    v_mfma_f32_16x16x32_bf16 v[80:83], v[144:147], v[212:215], v[80:83]
    v_mfma_f32_16x16x32_bf16 v[84:87], v[144:147], v[216:219], v[84:87]
    v_mfma_f32_16x16x32_bf16 v[88:91], v[144:147], v[220:223], v[88:91]
    v_mfma_f32_16x16x32_bf16 v[92:95], v[144:147], v[224:227], v[92:95]
    buffer_load_dwordx4 v[144:147], v15, s[12:15], s41 offen offset:0
    s_add_u32 m0, s31, 12288
    s_nop 0
    buffer_load_dwordx4 v2, s[8:11], s36 offen lds
    s_add_u32 m0, s31, 13312
    s_nop 0
    buffer_load_dwordx4 v3, s[8:11], s37 offen lds
    s_waitcnt vmcnt(34)
    v_mfma_f32_16x16x32_bf16 v[96:99], v[148:151], v[212:215], v[96:99]
    v_mfma_f32_16x16x32_bf16 v[100:103], v[148:151], v[216:219], v[100:103]
    v_mfma_f32_16x16x32_bf16 v[104:107], v[148:151], v[220:223], v[104:107]
    v_mfma_f32_16x16x32_bf16 v[108:111], v[148:151], v[224:227], v[108:111]
    buffer_load_dwordx4 v[148:151], v15, s[12:15], s41 offen offset:1024
    s_add_u32 m0, s31, 14336
    s_nop 0
    buffer_load_dwordx4 v2, s[8:11], s38 offen lds
    s_add_u32 m0, s31, 15360
    s_nop 0
    buffer_load_dwordx4 v3, s[8:11], s39 offen lds
    v_add_u32 v2, 128, v2
    v_add_u32 v3, 128, v3
    s_waitcnt vmcnt(36)
    v_mfma_f32_16x16x32_bf16 v[112:115], v[152:155], v[212:215], v[112:115]
    v_mfma_f32_16x16x32_bf16 v[116:119], v[152:155], v[216:219], v[116:119]
    v_mfma_f32_16x16x32_bf16 v[120:123], v[152:155], v[220:223], v[120:123]
    v_mfma_f32_16x16x32_bf16 v[124:127], v[152:155], v[224:227], v[124:127]
    buffer_load_dwordx4 v[152:155], v244, s[12:15], s41 offen
    s_waitcnt lgkmcnt(0)
    s_add_u32 s41, s40, 71680
    s_waitcnt vmcnt(36)
    v_mfma_f32_16x16x32_bf16 v[16:19], v[156:159], v[228:231], v[16:19]
    v_mfma_f32_16x16x32_bf16 v[20:23], v[156:159], v[232:235], v[20:23]
    v_mfma_f32_16x16x32_bf16 v[24:27], v[156:159], v[236:239], v[24:27]
    v_mfma_f32_16x16x32_bf16 v[28:31], v[156:159], v[240:243], v[28:31]
    buffer_load_dwordx4 v[156:159], v14, s[12:15], s41 offen offset:0
    s_waitcnt vmcnt(36)
    v_mfma_f32_16x16x32_bf16 v[32:35], v[160:163], v[228:231], v[32:35]
    v_mfma_f32_16x16x32_bf16 v[36:39], v[160:163], v[232:235], v[36:39]
    v_mfma_f32_16x16x32_bf16 v[40:43], v[160:163], v[236:239], v[40:43]
    v_mfma_f32_16x16x32_bf16 v[44:47], v[160:163], v[240:243], v[44:47]
    buffer_load_dwordx4 v[160:163], v14, s[12:15], s41 offen offset:1024
    s_waitcnt vmcnt(36)
    v_mfma_f32_16x16x32_bf16 v[48:51], v[164:167], v[228:231], v[48:51]
    v_mfma_f32_16x16x32_bf16 v[52:55], v[164:167], v[232:235], v[52:55]
    v_mfma_f32_16x16x32_bf16 v[56:59], v[164:167], v[236:239], v[56:59]
    v_mfma_f32_16x16x32_bf16 v[60:63], v[164:167], v[240:243], v[60:63]
    buffer_load_dwordx4 v[164:167], v14, s[12:15], s41 offen offset:2048
    s_waitcnt vmcnt(34)
    v_mfma_f32_16x16x32_bf16 v[64:67], v[168:171], v[228:231], v[64:67]
    v_mfma_f32_16x16x32_bf16 v[68:71], v[168:171], v[232:235], v[68:71]
    v_mfma_f32_16x16x32_bf16 v[72:75], v[168:171], v[236:239], v[72:75]
    v_mfma_f32_16x16x32_bf16 v[76:79], v[168:171], v[240:243], v[76:79]
    buffer_load_dwordx4 v[168:171], v14, s[12:15], s41 offen offset:3072
    s_waitcnt vmcnt(27)
    ds_read_b128 v[212:215], v4 offset:0
    ds_read_b128 v[216:219], v4 offset:2048
    ds_read_b128 v[220:223], v4 offset:4096
    ds_read_b128 v[224:227], v4 offset:6144
    v_mfma_f32_16x16x32_bf16 v[80:83], v[172:175], v[228:231], v[80:83]
    v_mfma_f32_16x16x32_bf16 v[84:87], v[172:175], v[232:235], v[84:87]
    v_mfma_f32_16x16x32_bf16 v[88:91], v[172:175], v[236:239], v[88:91]
    v_mfma_f32_16x16x32_bf16 v[92:95], v[172:175], v[240:243], v[92:95]
    buffer_load_dwordx4 v[172:175], v15, s[12:15], s41 offen offset:0
    v_mfma_f32_16x16x32_bf16 v[96:99], v[176:179], v[228:231], v[96:99]
    v_mfma_f32_16x16x32_bf16 v[100:103], v[176:179], v[232:235], v[100:103]
    v_mfma_f32_16x16x32_bf16 v[104:107], v[176:179], v[236:239], v[104:107]
    v_mfma_f32_16x16x32_bf16 v[108:111], v[176:179], v[240:243], v[108:111]
    buffer_load_dwordx4 v[176:179], v15, s[12:15], s41 offen offset:1024
    s_waitcnt vmcnt(28)
    v_mfma_f32_16x16x32_bf16 v[112:115], v[180:183], v[228:231], v[112:115]
    v_mfma_f32_16x16x32_bf16 v[116:119], v[180:183], v[232:235], v[116:119]
    v_mfma_f32_16x16x32_bf16 v[120:123], v[180:183], v[236:239], v[120:123]
    v_mfma_f32_16x16x32_bf16 v[124:127], v[180:183], v[240:243], v[124:127]
    buffer_load_dwordx4 v[180:183], v244, s[12:15], s41 offen
    s_waitcnt lgkmcnt(0)
    ds_read_b128 v[228:231], v5 offset:0
    ds_read_b128 v[232:235], v5 offset:2048
    ds_read_b128 v[236:239], v5 offset:4096
    ds_read_b128 v[240:243], v5 offset:6144
    s_add_u32 s41, s40, 78848
    s_waitcnt vmcnt(28)
    v_mfma_f32_16x16x32_bf16 v[16:19], v[184:187], v[212:215], v[16:19]
    v_mfma_f32_16x16x32_bf16 v[20:23], v[184:187], v[216:219], v[20:23]
    v_mfma_f32_16x16x32_bf16 v[24:27], v[184:187], v[220:223], v[24:27]
    v_mfma_f32_16x16x32_bf16 v[28:31], v[184:187], v[224:227], v[28:31]
    buffer_load_dwordx4 v[184:187], v14, s[12:15], s41 offen offset:0
    s_waitcnt vmcnt(28)
    v_mfma_f32_16x16x32_bf16 v[32:35], v[188:191], v[212:215], v[32:35]
    v_mfma_f32_16x16x32_bf16 v[36:39], v[188:191], v[216:219], v[36:39]
    v_mfma_f32_16x16x32_bf16 v[40:43], v[188:191], v[220:223], v[40:43]
    v_mfma_f32_16x16x32_bf16 v[44:47], v[188:191], v[224:227], v[44:47]
    buffer_load_dwordx4 v[188:191], v14, s[12:15], s41 offen offset:1024
    s_waitcnt lgkmcnt(0)
    s_waitcnt vmcnt(28)
    v_mfma_f32_16x16x32_bf16 v[48:51], v[192:195], v[212:215], v[48:51]
    v_mfma_f32_16x16x32_bf16 v[52:55], v[192:195], v[216:219], v[52:55]
    v_mfma_f32_16x16x32_bf16 v[56:59], v[192:195], v[220:223], v[56:59]
    v_mfma_f32_16x16x32_bf16 v[60:63], v[192:195], v[224:227], v[60:63]
    buffer_load_dwordx4 v[192:195], v14, s[12:15], s41 offen offset:2048
    s_add_u32 m0, s31, 0
    s_nop 0
    buffer_load_dwordx4 v2, s[8:11], s32 offen lds
    s_add_u32 m0, s31, 1024
    s_nop 0
    buffer_load_dwordx4 v3, s[8:11], s33 offen lds
    s_waitcnt vmcnt(30)
    v_mfma_f32_16x16x32_bf16 v[64:67], v[196:199], v[212:215], v[64:67]
    v_mfma_f32_16x16x32_bf16 v[68:71], v[196:199], v[216:219], v[68:71]
    v_mfma_f32_16x16x32_bf16 v[72:75], v[196:199], v[220:223], v[72:75]
    v_mfma_f32_16x16x32_bf16 v[76:79], v[196:199], v[224:227], v[76:79]
    buffer_load_dwordx4 v[196:199], v14, s[12:15], s41 offen offset:3072
    s_add_u32 m0, s31, 2048
    s_nop 0
    buffer_load_dwordx4 v2, s[8:11], s34 offen lds
    s_add_u32 m0, s31, 3072
    s_nop 0
    buffer_load_dwordx4 v3, s[8:11], s35 offen lds
    s_waitcnt vmcnt(32)
    v_mfma_f32_16x16x32_bf16 v[80:83], v[200:203], v[212:215], v[80:83]
    v_mfma_f32_16x16x32_bf16 v[84:87], v[200:203], v[216:219], v[84:87]
    v_mfma_f32_16x16x32_bf16 v[88:91], v[200:203], v[220:223], v[88:91]
    v_mfma_f32_16x16x32_bf16 v[92:95], v[200:203], v[224:227], v[92:95]
    buffer_load_dwordx4 v[200:203], v15, s[12:15], s41 offen offset:0
    s_add_u32 m0, s31, 4096
    s_nop 0
    buffer_load_dwordx4 v2, s[8:11], s36 offen lds
    s_add_u32 m0, s31, 5120
    s_nop 0
    buffer_load_dwordx4 v3, s[8:11], s37 offen lds
    s_waitcnt vmcnt(34)
    v_mfma_f32_16x16x32_bf16 v[96:99], v[204:207], v[212:215], v[96:99]
    v_mfma_f32_16x16x32_bf16 v[100:103], v[204:207], v[216:219], v[100:103]
    v_mfma_f32_16x16x32_bf16 v[104:107], v[204:207], v[220:223], v[104:107]
    v_mfma_f32_16x16x32_bf16 v[108:111], v[204:207], v[224:227], v[108:111]
    buffer_load_dwordx4 v[204:207], v15, s[12:15], s41 offen offset:1024
    s_add_u32 m0, s31, 6144
    s_nop 0
    buffer_load_dwordx4 v2, s[8:11], s38 offen lds
    s_add_u32 m0, s31, 7168
    s_nop 0
    buffer_load_dwordx4 v3, s[8:11], s39 offen lds
    v_add_u32 v2, 128, v2
    v_add_u32 v3, 128, v3
    s_waitcnt vmcnt(36)
    v_mfma_f32_16x16x32_bf16 v[112:115], v[208:211], v[212:215], v[112:115]
    v_mfma_f32_16x16x32_bf16 v[116:119], v[208:211], v[216:219], v[116:119]
    v_mfma_f32_16x16x32_bf16 v[120:123], v[208:211], v[220:223], v[120:123]
    v_mfma_f32_16x16x32_bf16 v[124:127], v[208:211], v[224:227], v[124:127]
    buffer_load_dwordx4 v[208:211], v244, s[12:15], s41 offen
    s_waitcnt lgkmcnt(0)
    s_add_u32 s41, s40, 86016
    s_waitcnt vmcnt(36)
    v_mfma_f32_16x16x32_bf16 v[16:19], v[128:131], v[228:231], v[16:19]
    v_mfma_f32_16x16x32_bf16 v[20:23], v[128:131], v[232:235], v[20:23]
    v_mfma_f32_16x16x32_bf16 v[24:27], v[128:131], v[236:239], v[24:27]
    v_mfma_f32_16x16x32_bf16 v[28:31], v[128:131], v[240:243], v[28:31]
    buffer_load_dwordx4 v[128:131], v14, s[12:15], s41 offen offset:0
    s_waitcnt vmcnt(36)
    v_mfma_f32_16x16x32_bf16 v[32:35], v[132:135], v[228:231], v[32:35]
    v_mfma_f32_16x16x32_bf16 v[36:39], v[132:135], v[232:235], v[36:39]
    v_mfma_f32_16x16x32_bf16 v[40:43], v[132:135], v[236:239], v[40:43]
    v_mfma_f32_16x16x32_bf16 v[44:47], v[132:135], v[240:243], v[44:47]
    buffer_load_dwordx4 v[132:135], v14, s[12:15], s41 offen offset:1024
    s_waitcnt vmcnt(36)
    v_mfma_f32_16x16x32_bf16 v[48:51], v[136:139], v[228:231], v[48:51]
    v_mfma_f32_16x16x32_bf16 v[52:55], v[136:139], v[232:235], v[52:55]
    v_mfma_f32_16x16x32_bf16 v[56:59], v[136:139], v[236:239], v[56:59]
    v_mfma_f32_16x16x32_bf16 v[60:63], v[136:139], v[240:243], v[60:63]
    buffer_load_dwordx4 v[136:139], v14, s[12:15], s41 offen offset:2048
    s_waitcnt vmcnt(34)
    v_mfma_f32_16x16x32_bf16 v[64:67], v[140:143], v[228:231], v[64:67]
    v_mfma_f32_16x16x32_bf16 v[68:71], v[140:143], v[232:235], v[68:71]
    v_mfma_f32_16x16x32_bf16 v[72:75], v[140:143], v[236:239], v[72:75]
    v_mfma_f32_16x16x32_bf16 v[76:79], v[140:143], v[240:243], v[76:79]
    buffer_load_dwordx4 v[140:143], v14, s[12:15], s41 offen offset:3072
    s_waitcnt vmcnt(27)
    ds_read_b128 v[212:215], v4 offset:8192
    ds_read_b128 v[216:219], v4 offset:10240
    ds_read_b128 v[220:223], v4 offset:12288
    ds_read_b128 v[224:227], v4 offset:14336
    v_mfma_f32_16x16x32_bf16 v[80:83], v[144:147], v[228:231], v[80:83]
    v_mfma_f32_16x16x32_bf16 v[84:87], v[144:147], v[232:235], v[84:87]
    v_mfma_f32_16x16x32_bf16 v[88:91], v[144:147], v[236:239], v[88:91]
    v_mfma_f32_16x16x32_bf16 v[92:95], v[144:147], v[240:243], v[92:95]
    buffer_load_dwordx4 v[144:147], v15, s[12:15], s41 offen offset:0
    v_mfma_f32_16x16x32_bf16 v[96:99], v[148:151], v[228:231], v[96:99]
    v_mfma_f32_16x16x32_bf16 v[100:103], v[148:151], v[232:235], v[100:103]
    v_mfma_f32_16x16x32_bf16 v[104:107], v[148:151], v[236:239], v[104:107]
    v_mfma_f32_16x16x32_bf16 v[108:111], v[148:151], v[240:243], v[108:111]
    buffer_load_dwordx4 v[148:151], v15, s[12:15], s41 offen offset:1024
    s_waitcnt vmcnt(28)
    v_mfma_f32_16x16x32_bf16 v[112:115], v[152:155], v[228:231], v[112:115]
    v_mfma_f32_16x16x32_bf16 v[116:119], v[152:155], v[232:235], v[116:119]
    v_mfma_f32_16x16x32_bf16 v[120:123], v[152:155], v[236:239], v[120:123]
    v_mfma_f32_16x16x32_bf16 v[124:127], v[152:155], v[240:243], v[124:127]
    buffer_load_dwordx4 v[152:155], v244, s[12:15], s41 offen
    s_waitcnt lgkmcnt(0)
    ds_read_b128 v[228:231], v5 offset:8192
    ds_read_b128 v[232:235], v5 offset:10240
    ds_read_b128 v[236:239], v5 offset:12288
    ds_read_b128 v[240:243], v5 offset:14336
    s_add_u32 s41, s40, 93184
    s_waitcnt vmcnt(28)
    v_mfma_f32_16x16x32_bf16 v[16:19], v[156:159], v[212:215], v[16:19]
    v_mfma_f32_16x16x32_bf16 v[20:23], v[156:159], v[216:219], v[20:23]
    v_mfma_f32_16x16x32_bf16 v[24:27], v[156:159], v[220:223], v[24:27]
    v_mfma_f32_16x16x32_bf16 v[28:31], v[156:159], v[224:227], v[28:31]
    buffer_load_dwordx4 v[156:159], v14, s[12:15], s41 offen offset:0
    s_waitcnt vmcnt(28)
    v_mfma_f32_16x16x32_bf16 v[32:35], v[160:163], v[212:215], v[32:35]
    v_mfma_f32_16x16x32_bf16 v[36:39], v[160:163], v[216:219], v[36:39]
    v_mfma_f32_16x16x32_bf16 v[40:43], v[160:163], v[220:223], v[40:43]
    v_mfma_f32_16x16x32_bf16 v[44:47], v[160:163], v[224:227], v[44:47]
    buffer_load_dwordx4 v[160:163], v14, s[12:15], s41 offen offset:1024
    s_waitcnt lgkmcnt(0)
    s_waitcnt vmcnt(28)
    v_mfma_f32_16x16x32_bf16 v[48:51], v[164:167], v[212:215], v[48:51]
    v_mfma_f32_16x16x32_bf16 v[52:55], v[164:167], v[216:219], v[52:55]
    v_mfma_f32_16x16x32_bf16 v[56:59], v[164:167], v[220:223], v[56:59]
    v_mfma_f32_16x16x32_bf16 v[60:63], v[164:167], v[224:227], v[60:63]
    buffer_load_dwordx4 v[164:167], v14, s[12:15], s41 offen offset:2048
    s_add_u32 m0, s31, 8192
    s_nop 0
    buffer_load_dwordx4 v2, s[8:11], s32 offen lds
    s_add_u32 m0, s31, 9216
    s_nop 0
    buffer_load_dwordx4 v3, s[8:11], s33 offen lds
    s_waitcnt vmcnt(30)
    v_mfma_f32_16x16x32_bf16 v[64:67], v[168:171], v[212:215], v[64:67]
    v_mfma_f32_16x16x32_bf16 v[68:71], v[168:171], v[216:219], v[68:71]
    v_mfma_f32_16x16x32_bf16 v[72:75], v[168:171], v[220:223], v[72:75]
    v_mfma_f32_16x16x32_bf16 v[76:79], v[168:171], v[224:227], v[76:79]
    buffer_load_dwordx4 v[168:171], v14, s[12:15], s41 offen offset:3072
    s_add_u32 m0, s31, 10240
    s_nop 0
    buffer_load_dwordx4 v2, s[8:11], s34 offen lds
    s_add_u32 m0, s31, 11264
    s_nop 0
    buffer_load_dwordx4 v3, s[8:11], s35 offen lds
    s_waitcnt vmcnt(32)
    v_mfma_f32_16x16x32_bf16 v[80:83], v[172:175], v[212:215], v[80:83]
    v_mfma_f32_16x16x32_bf16 v[84:87], v[172:175], v[216:219], v[84:87]
    v_mfma_f32_16x16x32_bf16 v[88:91], v[172:175], v[220:223], v[88:91]
    v_mfma_f32_16x16x32_bf16 v[92:95], v[172:175], v[224:227], v[92:95]
    buffer_load_dwordx4 v[172:175], v15, s[12:15], s41 offen offset:0
    s_add_u32 m0, s31, 12288
    s_nop 0
    buffer_load_dwordx4 v2, s[8:11], s36 offen lds
    s_add_u32 m0, s31, 13312
    s_nop 0
    buffer_load_dwordx4 v3, s[8:11], s37 offen lds
    s_waitcnt vmcnt(34)
    v_mfma_f32_16x16x32_bf16 v[96:99], v[176:179], v[212:215], v[96:99]
    v_mfma_f32_16x16x32_bf16 v[100:103], v[176:179], v[216:219], v[100:103]
    v_mfma_f32_16x16x32_bf16 v[104:107], v[176:179], v[220:223], v[104:107]
    v_mfma_f32_16x16x32_bf16 v[108:111], v[176:179], v[224:227], v[108:111]
    buffer_load_dwordx4 v[176:179], v15, s[12:15], s41 offen offset:1024
    s_add_u32 m0, s31, 14336
    s_nop 0
    buffer_load_dwordx4 v2, s[8:11], s38 offen lds
    s_add_u32 m0, s31, 15360
    s_nop 0
    buffer_load_dwordx4 v3, s[8:11], s39 offen lds
    v_add_u32 v2, 128, v2
    v_add_u32 v3, 128, v3
    s_waitcnt vmcnt(36)
    v_mfma_f32_16x16x32_bf16 v[112:115], v[180:183], v[212:215], v[112:115]
    v_mfma_f32_16x16x32_bf16 v[116:119], v[180:183], v[216:219], v[116:119]
    v_mfma_f32_16x16x32_bf16 v[120:123], v[180:183], v[220:223], v[120:123]
    v_mfma_f32_16x16x32_bf16 v[124:127], v[180:183], v[224:227], v[124:127]
    buffer_load_dwordx4 v[180:183], v244, s[12:15], s41 offen
    s_waitcnt lgkmcnt(0)
    s_add_u32 s41, s40, 100352
    s_waitcnt vmcnt(36)
    v_mfma_f32_16x16x32_bf16 v[16:19], v[184:187], v[228:231], v[16:19]
    v_mfma_f32_16x16x32_bf16 v[20:23], v[184:187], v[232:235], v[20:23]
    v_mfma_f32_16x16x32_bf16 v[24:27], v[184:187], v[236:239], v[24:27]
    v_mfma_f32_16x16x32_bf16 v[28:31], v[184:187], v[240:243], v[28:31]
    buffer_load_dwordx4 v[184:187], v14, s[12:15], s41 offen offset:0
    s_waitcnt vmcnt(36)
    v_mfma_f32_16x16x32_bf16 v[32:35], v[188:191], v[228:231], v[32:35]
    v_mfma_f32_16x16x32_bf16 v[36:39], v[188:191], v[232:235], v[36:39]
    v_mfma_f32_16x16x32_bf16 v[40:43], v[188:191], v[236:239], v[40:43]
    v_mfma_f32_16x16x32_bf16 v[44:47], v[188:191], v[240:243], v[44:47]
    buffer_load_dwordx4 v[188:191], v14, s[12:15], s41 offen offset:1024
    s_waitcnt vmcnt(36)
    v_mfma_f32_16x16x32_bf16 v[48:51], v[192:195], v[228:231], v[48:51]
    v_mfma_f32_16x16x32_bf16 v[52:55], v[192:195], v[232:235], v[52:55]
    v_mfma_f32_16x16x32_bf16 v[56:59], v[192:195], v[236:239], v[56:59]
    v_mfma_f32_16x16x32_bf16 v[60:63], v[192:195], v[240:243], v[60:63]
    buffer_load_dwordx4 v[192:195], v14, s[12:15], s41 offen offset:2048
    s_waitcnt vmcnt(34)
    v_mfma_f32_16x16x32_bf16 v[64:67], v[196:199], v[228:231], v[64:67]
    v_mfma_f32_16x16x32_bf16 v[68:71], v[196:199], v[232:235], v[68:71]
    v_mfma_f32_16x16x32_bf16 v[72:75], v[196:199], v[236:239], v[72:75]
    v_mfma_f32_16x16x32_bf16 v[76:79], v[196:199], v[240:243], v[76:79]
    buffer_load_dwordx4 v[196:199], v14, s[12:15], s41 offen offset:3072
    s_waitcnt vmcnt(27)
    ds_read_b128 v[212:215], v4 offset:0
    ds_read_b128 v[216:219], v4 offset:2048
    ds_read_b128 v[220:223], v4 offset:4096
    ds_read_b128 v[224:227], v4 offset:6144
    v_mfma_f32_16x16x32_bf16 v[80:83], v[200:203], v[228:231], v[80:83]
    v_mfma_f32_16x16x32_bf16 v[84:87], v[200:203], v[232:235], v[84:87]
    v_mfma_f32_16x16x32_bf16 v[88:91], v[200:203], v[236:239], v[88:91]
    v_mfma_f32_16x16x32_bf16 v[92:95], v[200:203], v[240:243], v[92:95]
    buffer_load_dwordx4 v[200:203], v15, s[12:15], s41 offen offset:0
    v_mfma_f32_16x16x32_bf16 v[96:99], v[204:207], v[228:231], v[96:99]
    v_mfma_f32_16x16x32_bf16 v[100:103], v[204:207], v[232:235], v[100:103]
    v_mfma_f32_16x16x32_bf16 v[104:107], v[204:207], v[236:239], v[104:107]
    v_mfma_f32_16x16x32_bf16 v[108:111], v[204:207], v[240:243], v[108:111]
    buffer_load_dwordx4 v[204:207], v15, s[12:15], s41 offen offset:1024
    s_waitcnt vmcnt(28)
    v_mfma_f32_16x16x32_bf16 v[112:115], v[208:211], v[228:231], v[112:115]
    v_mfma_f32_16x16x32_bf16 v[116:119], v[208:211], v[232:235], v[116:119]
    v_mfma_f32_16x16x32_bf16 v[120:123], v[208:211], v[236:239], v[120:123]
    v_mfma_f32_16x16x32_bf16 v[124:127], v[208:211], v[240:243], v[124:127]
    buffer_load_dwordx4 v[208:211], v244, s[12:15], s41 offen
    s_waitcnt lgkmcnt(0)
    ds_read_b128 v[228:231], v5 offset:0
    ds_read_b128 v[232:235], v5 offset:2048
    ds_read_b128 v[236:239], v5 offset:4096
    ds_read_b128 v[240:243], v5 offset:6144
    s_add_u32 s41, s40, 107520
    s_waitcnt vmcnt(28)
    v_mfma_f32_16x16x32_bf16 v[16:19], v[128:131], v[212:215], v[16:19]
    v_mfma_f32_16x16x32_bf16 v[20:23], v[128:131], v[216:219], v[20:23]
    v_mfma_f32_16x16x32_bf16 v[24:27], v[128:131], v[220:223], v[24:27]
    v_mfma_f32_16x16x32_bf16 v[28:31], v[128:131], v[224:227], v[28:31]
    buffer_load_dwordx4 v[128:131], v14, s[12:15], s41 offen offset:0
    s_waitcnt vmcnt(28)
    v_mfma_f32_16x16x32_bf16 v[32:35], v[132:135], v[212:215], v[32:35]
    v_mfma_f32_16x16x32_bf16 v[36:39], v[132:135], v[216:219], v[36:39]
    v_mfma_f32_16x16x32_bf16 v[40:43], v[132:135], v[220:223], v[40:43]
    v_mfma_f32_16x16x32_bf16 v[44:47], v[132:135], v[224:227], v[44:47]
    buffer_load_dwordx4 v[132:135], v14, s[12:15], s41 offen offset:1024
    s_waitcnt vmcnt(28)
    v_mfma_f32_16x16x32_bf16 v[48:51], v[136:139], v[212:215], v[48:51]
    v_mfma_f32_16x16x32_bf16 v[52:55], v[136:139], v[216:219], v[52:55]
    v_mfma_f32_16x16x32_bf16 v[56:59], v[136:139], v[220:223], v[56:59]
    v_mfma_f32_16x16x32_bf16 v[60:63], v[136:139], v[224:227], v[60:63]
    buffer_load_dwordx4 v[136:139], v14, s[12:15], s41 offen offset:2048
    s_waitcnt vmcnt(28)
    v_mfma_f32_16x16x32_bf16 v[64:67], v[140:143], v[212:215], v[64:67]
    v_mfma_f32_16x16x32_bf16 v[68:71], v[140:143], v[216:219], v[68:71]
    v_mfma_f32_16x16x32_bf16 v[72:75], v[140:143], v[220:223], v[72:75]
    v_mfma_f32_16x16x32_bf16 v[76:79], v[140:143], v[224:227], v[76:79]
    buffer_load_dwordx4 v[140:143], v14, s[12:15], s41 offen offset:3072
    s_waitcnt vmcnt(28)
    v_mfma_f32_16x16x32_bf16 v[80:83], v[144:147], v[212:215], v[80:83]
    v_mfma_f32_16x16x32_bf16 v[84:87], v[144:147], v[216:219], v[84:87]
    v_mfma_f32_16x16x32_bf16 v[88:91], v[144:147], v[220:223], v[88:91]
    v_mfma_f32_16x16x32_bf16 v[92:95], v[144:147], v[224:227], v[92:95]
    buffer_load_dwordx4 v[144:147], v15, s[12:15], s41 offen offset:0
    s_waitcnt vmcnt(28)
    v_mfma_f32_16x16x32_bf16 v[96:99], v[148:151], v[212:215], v[96:99]
    v_mfma_f32_16x16x32_bf16 v[100:103], v[148:151], v[216:219], v[100:103]
    v_mfma_f32_16x16x32_bf16 v[104:107], v[148:151], v[220:223], v[104:107]
    v_mfma_f32_16x16x32_bf16 v[108:111], v[148:151], v[224:227], v[108:111]
    buffer_load_dwordx4 v[148:151], v15, s[12:15], s41 offen offset:1024
    s_waitcnt vmcnt(28)
    v_mfma_f32_16x16x32_bf16 v[112:115], v[152:155], v[212:215], v[112:115]
    v_mfma_f32_16x16x32_bf16 v[116:119], v[152:155], v[216:219], v[116:119]
    v_mfma_f32_16x16x32_bf16 v[120:123], v[152:155], v[220:223], v[120:123]
    v_mfma_f32_16x16x32_bf16 v[124:127], v[152:155], v[224:227], v[124:127]
    buffer_load_dwordx4 v[152:155], v244, s[12:15], s41 offen
    s_waitcnt lgkmcnt(0)
    s_waitcnt vmcnt(28)
    v_mfma_f32_16x16x32_bf16 v[16:19], v[156:159], v[228:231], v[16:19]
    v_mfma_f32_16x16x32_bf16 v[20:23], v[156:159], v[232:235], v[20:23]
    v_mfma_f32_16x16x32_bf16 v[24:27], v[156:159], v[236:239], v[24:27]
    v_mfma_f32_16x16x32_bf16 v[28:31], v[156:159], v[240:243], v[28:31]
    v_lshlrev_b32 v14, 3, v1
    v_add_u32 v14, 0x400000, v14
    v_and_b32 v15, 15, v1
    v_mul_u32_u24 v15, 896, v15
    v_lshl_add_u32 v15, v10, 4, v15
    s_waitcnt vmcnt(27)
    v_mfma_f32_16x16x32_bf16 v[32:35], v[160:163], v[228:231], v[32:35]
    v_mfma_f32_16x16x32_bf16 v[36:39], v[160:163], v[232:235], v[36:39]
    v_mfma_f32_16x16x32_bf16 v[40:43], v[160:163], v[236:239], v[40:43]
    v_mfma_f32_16x16x32_bf16 v[44:47], v[160:163], v[240:243], v[44:47]
    s_lshl_b32 s42, s28, 11
    s_add_u32 m0, s42, 73728
    s_add_u32 s42, s54, 0
    buffer_load_dwordx4 v15, s[20:23], s42 offen lds
    s_waitcnt vmcnt(27)
    v_mfma_f32_16x16x32_bf16 v[48:51], v[164:167], v[228:231], v[48:51]
    v_mfma_f32_16x16x32_bf16 v[52:55], v[164:167], v[232:235], v[52:55]
    v_mfma_f32_16x16x32_bf16 v[56:59], v[164:167], v[236:239], v[56:59]
    v_mfma_f32_16x16x32_bf16 v[60:63], v[164:167], v[240:243], v[60:63]
    s_waitcnt vmcnt(24)
    v_mfma_f32_16x16x32_bf16 v[64:67], v[168:171], v[228:231], v[64:67]
    v_mfma_f32_16x16x32_bf16 v[68:71], v[168:171], v[232:235], v[68:71]
    v_mfma_f32_16x16x32_bf16 v[72:75], v[168:171], v[236:239], v[72:75]
    v_mfma_f32_16x16x32_bf16 v[76:79], v[168:171], v[240:243], v[76:79]
    s_waitcnt vmcnt(16)
    ds_read_b128 v[212:215], v4 offset:8192
    ds_read_b128 v[216:219], v4 offset:10240
    ds_read_b128 v[220:223], v4 offset:12288
    ds_read_b128 v[224:227], v4 offset:14336
    s_lshl_b32 s42, s28, 11
    s_add_u32 m0, s42, 74752
    s_add_u32 s42, s54, 64
    buffer_load_dwordx4 v15, s[20:23], s42 offen lds
    v_mfma_f32_16x16x32_bf16 v[80:83], v[172:175], v[228:231], v[80:83]
    v_mfma_f32_16x16x32_bf16 v[84:87], v[172:175], v[232:235], v[84:87]
    v_mfma_f32_16x16x32_bf16 v[88:91], v[172:175], v[236:239], v[88:91]
    v_mfma_f32_16x16x32_bf16 v[92:95], v[172:175], v[240:243], v[92:95]
    v_mfma_f32_16x16x32_bf16 v[96:99], v[176:179], v[228:231], v[96:99]
    v_mfma_f32_16x16x32_bf16 v[100:103], v[176:179], v[232:235], v[100:103]
    v_mfma_f32_16x16x32_bf16 v[104:107], v[176:179], v[236:239], v[104:107]
    v_mfma_f32_16x16x32_bf16 v[108:111], v[176:179], v[240:243], v[108:111]
    s_waitcnt vmcnt(16)
    v_mfma_f32_16x16x32_bf16 v[112:115], v[180:183], v[228:231], v[112:115]
    v_mfma_f32_16x16x32_bf16 v[116:119], v[180:183], v[232:235], v[116:119]
    v_mfma_f32_16x16x32_bf16 v[120:123], v[180:183], v[236:239], v[120:123]
    v_mfma_f32_16x16x32_bf16 v[124:127], v[180:183], v[240:243], v[124:127]
    s_waitcnt lgkmcnt(0)
    ds_read_b128 v[228:231], v5 offset:8192
    ds_read_b128 v[232:235], v5 offset:10240
    ds_read_b128 v[236:239], v5 offset:12288
    ds_read_b128 v[240:243], v5 offset:14336
    s_waitcnt vmcnt(15)
    v_mfma_f32_16x16x32_bf16 v[16:19], v[184:187], v[212:215], v[16:19]
    v_mfma_f32_16x16x32_bf16 v[20:23], v[184:187], v[216:219], v[20:23]
    v_mfma_f32_16x16x32_bf16 v[24:27], v[184:187], v[220:223], v[24:27]
    v_mfma_f32_16x16x32_bf16 v[28:31], v[184:187], v[224:227], v[28:31]
    buffer_load_dwordx4 v[156:159], v6, s[12:15], s50 offen
    s_waitcnt vmcnt(15)
    v_mfma_f32_16x16x32_bf16 v[32:35], v[188:191], v[212:215], v[32:35]
    v_mfma_f32_16x16x32_bf16 v[36:39], v[188:191], v[216:219], v[36:39]
    v_mfma_f32_16x16x32_bf16 v[40:43], v[188:191], v[220:223], v[40:43]
    v_mfma_f32_16x16x32_bf16 v[44:47], v[188:191], v[224:227], v[44:47]
    buffer_load_ushort v13, v12, s[16:19], s57 offen
    s_waitcnt vmcnt(15)
    v_mfma_f32_16x16x32_bf16 v[48:51], v[192:195], v[212:215], v[48:51]
    v_mfma_f32_16x16x32_bf16 v[52:55], v[192:195], v[216:219], v[52:55]
    v_mfma_f32_16x16x32_bf16 v[56:59], v[192:195], v[220:223], v[56:59]
    v_mfma_f32_16x16x32_bf16 v[60:63], v[192:195], v[224:227], v[60:63]
    buffer_load_dwordx4 v[160:163], v6, s[12:15], s51 offen
    s_waitcnt vmcnt(15)
    v_mfma_f32_16x16x32_bf16 v[64:67], v[196:199], v[212:215], v[64:67]
    v_mfma_f32_16x16x32_bf16 v[68:71], v[196:199], v[216:219], v[68:71]
    v_mfma_f32_16x16x32_bf16 v[72:75], v[196:199], v[220:223], v[72:75]
    v_mfma_f32_16x16x32_bf16 v[76:79], v[196:199], v[224:227], v[76:79]
    s_waitcnt vmcnt(14)
    v_mfma_f32_16x16x32_bf16 v[80:83], v[200:203], v[212:215], v[80:83]
    v_mfma_f32_16x16x32_bf16 v[84:87], v[200:203], v[216:219], v[84:87]
    v_mfma_f32_16x16x32_bf16 v[88:91], v[200:203], v[220:223], v[88:91]
    v_mfma_f32_16x16x32_bf16 v[92:95], v[200:203], v[224:227], v[92:95]
    buffer_load_dwordx4 v[164:167], v6, s[12:15], s52 offen
    s_waitcnt vmcnt(14)
    v_mfma_f32_16x16x32_bf16 v[96:99], v[204:207], v[212:215], v[96:99]
    v_mfma_f32_16x16x32_bf16 v[100:103], v[204:207], v[216:219], v[100:103]
    v_mfma_f32_16x16x32_bf16 v[104:107], v[204:207], v[220:223], v[104:107]
    v_mfma_f32_16x16x32_bf16 v[108:111], v[204:207], v[224:227], v[108:111]
    s_waitcnt vmcnt(13)
    v_mfma_f32_16x16x32_bf16 v[112:115], v[208:211], v[212:215], v[112:115]
    v_mfma_f32_16x16x32_bf16 v[116:119], v[208:211], v[216:219], v[116:119]
    v_mfma_f32_16x16x32_bf16 v[120:123], v[208:211], v[220:223], v[120:123]
    v_mfma_f32_16x16x32_bf16 v[124:127], v[208:211], v[224:227], v[124:127]
    buffer_load_dwordx2 v[168:169], v6, s[12:15], s53 offen
    s_waitcnt lgkmcnt(0)
    s_waitcnt vmcnt(13)
    v_mfma_f32_16x16x32_bf16 v[20:23], v[128:131], v[232:235], v[20:23]
    v_mfma_f32_16x16x32_bf16 v[28:31], v[128:131], v[240:243], v[28:31]
    s_waitcnt vmcnt(12)
    v_mfma_f32_16x16x32_bf16 v[36:39], v[132:135], v[232:235], v[36:39]
    v_mfma_f32_16x16x32_bf16 v[44:47], v[132:135], v[240:243], v[44:47]
    s_waitcnt vmcnt(11)
    v_mfma_f32_16x16x32_bf16 v[52:55], v[136:139], v[232:235], v[52:55]
    v_mfma_f32_16x16x32_bf16 v[60:63], v[136:139], v[240:243], v[60:63]
    s_waitcnt vmcnt(10)
    v_mfma_f32_16x16x32_bf16 v[68:71], v[140:143], v[232:235], v[68:71]
    v_mfma_f32_16x16x32_bf16 v[76:79], v[140:143], v[240:243], v[76:79]
    s_waitcnt vmcnt(9)
    v_mfma_f32_16x16x32_bf16 v[84:87], v[144:147], v[232:235], v[84:87]
    v_mfma_f32_16x16x32_bf16 v[92:95], v[144:147], v[240:243], v[92:95]
    s_waitcnt vmcnt(8)
    v_mfma_f32_16x16x32_bf16 v[100:103], v[148:151], v[232:235], v[100:103]
    v_mfma_f32_16x16x32_bf16 v[108:111], v[148:151], v[240:243], v[108:111]
    s_waitcnt vmcnt(7)
    v_mfma_f32_16x16x32_bf16 v[116:119], v[152:155], v[232:235], v[116:119]
    v_mfma_f32_16x16x32_bf16 v[124:127], v[152:155], v[240:243], v[124:127]
    v_add_u32 v8, s31, v6
    v_xor_b32 v9, 0x4000, v8
    v_xor_b32 v10, 0xC000, v8
    v_mfma_f32_16x16x32_bf16 v[16:19], v[128:131], v[228:231], v[16:19]
    v_mfma_f32_16x16x32_bf16 v[24:27], v[128:131], v[236:239], v[24:27]
    ds_write_b128 v8, v[20:23] offset:0
    ds_write_b128 v8, v[28:31] offset:1024
    v_mfma_f32_16x16x32_bf16 v[32:35], v[132:135], v[228:231], v[32:35]
    v_mfma_f32_16x16x32_bf16 v[40:43], v[132:135], v[236:239], v[40:43]
    ds_write_b128 v8, v[36:39] offset:2048
    ds_write_b128 v8, v[44:47] offset:3072
    v_mfma_f32_16x16x32_bf16 v[48:51], v[136:139], v[228:231], v[48:51]
    v_mfma_f32_16x16x32_bf16 v[56:59], v[136:139], v[236:239], v[56:59]
    ds_write_b128 v8, v[52:55] offset:4096
    ds_write_b128 v8, v[60:63] offset:5120
    v_mfma_f32_16x16x32_bf16 v[64:67], v[140:143], v[228:231], v[64:67]
    v_mfma_f32_16x16x32_bf16 v[72:75], v[140:143], v[236:239], v[72:75]
    ds_write_b128 v8, v[68:71] offset:6144
    ds_write_b128 v8, v[76:79] offset:7168
    v_mfma_f32_16x16x32_bf16 v[80:83], v[144:147], v[228:231], v[80:83]
    v_mfma_f32_16x16x32_bf16 v[88:91], v[144:147], v[236:239], v[88:91]
    ds_write_b128 v8, v[84:87] offset:8192
    ds_write_b128 v8, v[92:95] offset:9216
    v_mfma_f32_16x16x32_bf16 v[96:99], v[148:151], v[228:231], v[96:99]
    v_mfma_f32_16x16x32_bf16 v[104:107], v[148:151], v[236:239], v[104:107]
    ds_write_b128 v8, v[100:103] offset:10240
    ds_write_b128 v8, v[108:111] offset:11264
    v_mfma_f32_16x16x32_bf16 v[112:115], v[152:155], v[228:231], v[112:115]
    v_mfma_f32_16x16x32_bf16 v[120:123], v[152:155], v[236:239], v[120:123]
    ds_write_b128 v8, v[116:119] offset:12288
    ds_write_b128 v8, v[124:127] offset:13312
    s_lshl_b32 s43, s29, 10
    s_lshl_b32 s42, s30, 7
    s_add_u32 s42, s42, s43
    s_lshl_b32 s48, s28, 2
    s_add_u32 s42, s42, s48
    s_add_u32 s42, s42, 18087936
    buffer_load_dwordx4 v[172:175], v6, s[12:15], s88 offen offset:0
    buffer_load_dwordx4 v[176:179], v6, s[12:15], s89 offen offset:0
    buffer_load_dwordx4 v[180:183], v6, s[12:15], s90 offen offset:0
    buffer_load_dwordx4 v[244:247], v6, s[12:15], s91 offen offset:0
    buffer_load_dwordx4 v[248:251], v6, s[12:15], s88 offen offset:1024
    buffer_load_dwordx4 v[252:255], v6, s[12:15], s89 offen offset:1024
    buffer_load_dwordx4 v[184:187], v6, s[12:15], s90 offen offset:1024
    buffer_load_dwordx4 v[188:191], v6, s[12:15], s91 offen offset:1024
    s_waitcnt lgkmcnt(0)
    s_barrier
    ds_read_b128 v[20:23], v9 offset:0
    ds_read_b128 v[28:31], v9 offset:1024
    ds_read_b128 v[36:39], v9 offset:2048
    ds_read_b128 v[44:47], v9 offset:3072
    ds_read_b128 v[52:55], v9 offset:4096
    ds_read_b128 v[60:63], v9 offset:5120
    ds_read_b128 v[68:71], v9 offset:6144
    ds_read_b128 v[76:79], v9 offset:7168
    ds_read_b128 v[84:87], v9 offset:8192
    ds_read_b128 v[92:95], v9 offset:9216
    ds_read_b128 v[100:103], v9 offset:10240
    ds_read_b128 v[108:111], v9 offset:11264
    ds_read_b128 v[116:119], v9 offset:12288
    ds_read_b128 v[124:127], v9 offset:13312
    s_waitcnt lgkmcnt(12)
    v_pk_add_f32 v[16:17], v[16:17], v[20:21]
    v_pk_add_f32 v[18:19], v[18:19], v[22:23]
    v_pk_add_f32 v[24:25], v[24:25], v[28:29]
    v_pk_add_f32 v[26:27], v[26:27], v[30:31]
    s_waitcnt lgkmcnt(10)
    v_pk_add_f32 v[32:33], v[32:33], v[36:37]
    v_pk_add_f32 v[34:35], v[34:35], v[38:39]
    v_pk_add_f32 v[40:41], v[40:41], v[44:45]
    v_pk_add_f32 v[42:43], v[42:43], v[46:47]
    s_waitcnt lgkmcnt(8)
    v_pk_add_f32 v[48:49], v[48:49], v[52:53]
    v_pk_add_f32 v[50:51], v[50:51], v[54:55]
    v_pk_add_f32 v[56:57], v[56:57], v[60:61]
    v_pk_add_f32 v[58:59], v[58:59], v[62:63]
    s_waitcnt lgkmcnt(6)
    v_pk_add_f32 v[64:65], v[64:65], v[68:69]
    v_pk_add_f32 v[66:67], v[66:67], v[70:71]
    v_pk_add_f32 v[72:73], v[72:73], v[76:77]
    v_pk_add_f32 v[74:75], v[74:75], v[78:79]
    s_waitcnt lgkmcnt(4)
    v_pk_add_f32 v[80:81], v[80:81], v[84:85]
    v_pk_add_f32 v[82:83], v[82:83], v[86:87]
    v_pk_add_f32 v[88:89], v[88:89], v[92:93]
    v_pk_add_f32 v[90:91], v[90:91], v[94:95]
    s_waitcnt lgkmcnt(2)
    v_pk_add_f32 v[96:97], v[96:97], v[100:101]
    v_pk_add_f32 v[98:99], v[98:99], v[102:103]
    v_pk_add_f32 v[104:105], v[104:105], v[108:109]
    v_pk_add_f32 v[106:107], v[106:107], v[110:111]
    s_waitcnt lgkmcnt(0)
    v_pk_add_f32 v[112:113], v[112:113], v[116:117]
    v_pk_add_f32 v[114:115], v[114:115], v[118:119]
    v_pk_add_f32 v[120:121], v[120:121], v[124:125]
    v_pk_add_f32 v[122:123], v[122:123], v[126:127]
    ds_write_b128 v9, v[24:27] offset:0
    ds_write_b128 v9, v[40:43] offset:1024
    ds_write_b128 v9, v[56:59] offset:2048
    ds_write_b128 v9, v[72:75] offset:3072
    ds_write_b128 v9, v[88:91] offset:4096
    ds_write_b128 v9, v[104:107] offset:5120
    ds_write_b128 v9, v[120:123] offset:6144
    buffer_load_dwordx4 v[192:195], v6, s[12:15], s88 offen offset:2048
    buffer_load_dwordx4 v[196:199], v6, s[12:15], s89 offen offset:2048
    buffer_load_dwordx4 v[200:203], v6, s[12:15], s90 offen offset:2048
    buffer_load_dwordx4 v[204:207], v6, s[12:15], s91 offen offset:2048
    buffer_load_dwordx4 v[208:211], v6, s[12:15], s88 offen offset:3072
    buffer_load_dwordx4 v[212:215], v6, s[12:15], s89 offen offset:3072
    buffer_load_dwordx4 v[216:219], v6, s[12:15], s90 offen offset:3072
    buffer_load_dwordx4 v[220:223], v6, s[12:15], s91 offen offset:3072
    s_waitcnt vmcnt(16)
    v_lshlrev_b32 v13, 16, v13
    v_lshlrev_b32 v128, 16, v156
    v_and_b32 v129, 0xffff0000, v156
    v_lshlrev_b32 v130, 16, v157
    v_and_b32 v131, 0xffff0000, v157
    v_lshlrev_b32 v132, 16, v158
    v_and_b32 v133, 0xffff0000, v158
    v_lshlrev_b32 v134, 16, v159
    v_and_b32 v135, 0xffff0000, v159
    v_lshlrev_b32 v136, 16, v160
    v_and_b32 v137, 0xffff0000, v160
    v_lshlrev_b32 v138, 16, v161
    v_and_b32 v139, 0xffff0000, v161
    v_lshlrev_b32 v140, 16, v162
    v_and_b32 v141, 0xffff0000, v162
    v_lshlrev_b32 v142, 16, v163
    v_and_b32 v143, 0xffff0000, v163
    v_lshlrev_b32 v144, 16, v164
    v_and_b32 v145, 0xffff0000, v164
    v_lshlrev_b32 v146, 16, v165
    v_and_b32 v147, 0xffff0000, v165
    v_lshlrev_b32 v148, 16, v166
    v_and_b32 v149, 0xffff0000, v166
    v_lshlrev_b32 v150, 16, v167
    v_and_b32 v151, 0xffff0000, v167
    v_lshlrev_b32 v152, 16, v168
    v_and_b32 v153, 0xffff0000, v168
    v_lshlrev_b32 v154, 16, v169
    v_and_b32 v155, 0xffff0000, v169
    s_waitcnt lgkmcnt(0)
    s_barrier
    ds_read_b128 v[28:31], v10 offset:0
    ds_read_b128 v[44:47], v10 offset:1024
    ds_read_b128 v[60:63], v10 offset:2048
    ds_read_b128 v[76:79], v10 offset:3072
    ds_read_b128 v[92:95], v10 offset:4096
    ds_read_b128 v[108:111], v10 offset:5120
    ds_read_b128 v[124:127], v10 offset:6144
    s_waitcnt lgkmcnt(6)
    v_pk_add_f32 v[16:17], v[16:17], v[28:29]
    v_pk_add_f32 v[18:19], v[18:19], v[30:31]
    v_cvt_pk_bf16_f32 v20, v16, v17
    v_cvt_pk_bf16_f32 v21, v18, v19
    v_lshlrev_b32 v16, 16, v20
    v_and_b32 v17, 0xffff0000, v20
    v_lshlrev_b32 v18, 16, v21
    v_and_b32 v19, 0xffff0000, v21
    v_pk_add_f32 v[16:17], v[16:17], v[12:13] op_sel:[0,1] op_sel_hi:[1,1]
    v_pk_add_f32 v[18:19], v[18:19], v[12:13] op_sel:[0,1] op_sel_hi:[1,1]
    v_cvt_pk_bf16_f32 v20, v16, v17
    v_cvt_pk_bf16_f32 v21, v18, v19
    v_lshlrev_b32 v16, 16, v20
    v_and_b32 v17, 0xffff0000, v20
    v_lshlrev_b32 v18, 16, v21
    v_and_b32 v19, 0xffff0000, v21
    v_pk_mul_f32 v[16:17], v[16:17], v[128:129]
    v_pk_mul_f32 v[18:19], v[18:19], v[130:131]
    v_cvt_pk_bf16_f32 v24, v16, v17
    v_cvt_pk_bf16_f32 v25, v18, v19
    s_waitcnt lgkmcnt(5)
    v_pk_add_f32 v[32:33], v[32:33], v[44:45]
    v_pk_add_f32 v[34:35], v[34:35], v[46:47]
    v_cvt_pk_bf16_f32 v36, v32, v33
    v_cvt_pk_bf16_f32 v37, v34, v35
    v_lshlrev_b32 v32, 16, v36
    v_and_b32 v33, 0xffff0000, v36
    v_lshlrev_b32 v34, 16, v37
    v_and_b32 v35, 0xffff0000, v37
    v_pk_add_f32 v[32:33], v[32:33], v[12:13] op_sel:[0,1] op_sel_hi:[1,1]
    v_pk_add_f32 v[34:35], v[34:35], v[12:13] op_sel:[0,1] op_sel_hi:[1,1]
    v_cvt_pk_bf16_f32 v36, v32, v33
    v_cvt_pk_bf16_f32 v37, v34, v35
    v_lshlrev_b32 v32, 16, v36
    v_and_b32 v33, 0xffff0000, v36
    v_lshlrev_b32 v34, 16, v37
    v_and_b32 v35, 0xffff0000, v37
    v_pk_mul_f32 v[32:33], v[32:33], v[132:133]
    v_pk_mul_f32 v[34:35], v[34:35], v[134:135]
    v_cvt_pk_bf16_f32 v26, v32, v33
    v_cvt_pk_bf16_f32 v27, v34, v35
    buffer_store_dwordx4 v[24:27], v11, s[12:15], s50 offen sc1
    s_waitcnt lgkmcnt(4)
    v_pk_add_f32 v[48:49], v[48:49], v[60:61]
    v_pk_add_f32 v[50:51], v[50:51], v[62:63]
    v_cvt_pk_bf16_f32 v52, v48, v49
    v_cvt_pk_bf16_f32 v53, v50, v51
    v_lshlrev_b32 v48, 16, v52
    v_and_b32 v49, 0xffff0000, v52
    v_lshlrev_b32 v50, 16, v53
    v_and_b32 v51, 0xffff0000, v53
    v_pk_add_f32 v[48:49], v[48:49], v[12:13] op_sel:[0,1] op_sel_hi:[1,1]
    v_pk_add_f32 v[50:51], v[50:51], v[12:13] op_sel:[0,1] op_sel_hi:[1,1]
    v_cvt_pk_bf16_f32 v52, v48, v49
    v_cvt_pk_bf16_f32 v53, v50, v51
    v_lshlrev_b32 v48, 16, v52
    v_and_b32 v49, 0xffff0000, v52
    v_lshlrev_b32 v50, 16, v53
    v_and_b32 v51, 0xffff0000, v53
    v_pk_mul_f32 v[48:49], v[48:49], v[136:137]
    v_pk_mul_f32 v[50:51], v[50:51], v[138:139]
    v_cvt_pk_bf16_f32 v56, v48, v49
    v_cvt_pk_bf16_f32 v57, v50, v51
    s_waitcnt lgkmcnt(3)
    v_pk_add_f32 v[64:65], v[64:65], v[76:77]
    v_pk_add_f32 v[66:67], v[66:67], v[78:79]
    v_cvt_pk_bf16_f32 v68, v64, v65
    v_cvt_pk_bf16_f32 v69, v66, v67
    v_lshlrev_b32 v64, 16, v68
    v_and_b32 v65, 0xffff0000, v68
    v_lshlrev_b32 v66, 16, v69
    v_and_b32 v67, 0xffff0000, v69
    v_pk_add_f32 v[64:65], v[64:65], v[12:13] op_sel:[0,1] op_sel_hi:[1,1]
    v_pk_add_f32 v[66:67], v[66:67], v[12:13] op_sel:[0,1] op_sel_hi:[1,1]
    v_cvt_pk_bf16_f32 v68, v64, v65
    v_cvt_pk_bf16_f32 v69, v66, v67
    v_lshlrev_b32 v64, 16, v68
    v_and_b32 v65, 0xffff0000, v68
    v_lshlrev_b32 v66, 16, v69
    v_and_b32 v67, 0xffff0000, v69
    v_pk_mul_f32 v[64:65], v[64:65], v[140:141]
    v_pk_mul_f32 v[66:67], v[66:67], v[142:143]
    v_cvt_pk_bf16_f32 v58, v64, v65
    v_cvt_pk_bf16_f32 v59, v66, v67
    buffer_store_dwordx4 v[56:59], v11, s[12:15], s51 offen sc1
    s_waitcnt lgkmcnt(2)
    v_pk_add_f32 v[80:81], v[80:81], v[92:93]
    v_pk_add_f32 v[82:83], v[82:83], v[94:95]
    v_cvt_pk_bf16_f32 v84, v80, v81
    v_cvt_pk_bf16_f32 v85, v82, v83
    v_lshlrev_b32 v80, 16, v84
    v_and_b32 v81, 0xffff0000, v84
    v_lshlrev_b32 v82, 16, v85
    v_and_b32 v83, 0xffff0000, v85
    v_pk_add_f32 v[80:81], v[80:81], v[12:13] op_sel:[0,1] op_sel_hi:[1,1]
    v_pk_add_f32 v[82:83], v[82:83], v[12:13] op_sel:[0,1] op_sel_hi:[1,1]
    v_cvt_pk_bf16_f32 v84, v80, v81
    v_cvt_pk_bf16_f32 v85, v82, v83
    v_lshlrev_b32 v80, 16, v84
    v_and_b32 v81, 0xffff0000, v84
    v_lshlrev_b32 v82, 16, v85
    v_and_b32 v83, 0xffff0000, v85
    v_pk_mul_f32 v[80:81], v[80:81], v[144:145]
    v_pk_mul_f32 v[82:83], v[82:83], v[146:147]
    v_cvt_pk_bf16_f32 v88, v80, v81
    v_cvt_pk_bf16_f32 v89, v82, v83
    s_waitcnt lgkmcnt(1)
    v_pk_add_f32 v[96:97], v[96:97], v[108:109]
    v_pk_add_f32 v[98:99], v[98:99], v[110:111]
    v_cvt_pk_bf16_f32 v100, v96, v97
    v_cvt_pk_bf16_f32 v101, v98, v99
    v_lshlrev_b32 v96, 16, v100
    v_and_b32 v97, 0xffff0000, v100
    v_lshlrev_b32 v98, 16, v101
    v_and_b32 v99, 0xffff0000, v101
    v_pk_add_f32 v[96:97], v[96:97], v[12:13] op_sel:[0,1] op_sel_hi:[1,1]
    v_pk_add_f32 v[98:99], v[98:99], v[12:13] op_sel:[0,1] op_sel_hi:[1,1]
    v_cvt_pk_bf16_f32 v100, v96, v97
    v_cvt_pk_bf16_f32 v101, v98, v99
    v_lshlrev_b32 v96, 16, v100
    v_and_b32 v97, 0xffff0000, v100
    v_lshlrev_b32 v98, 16, v101
    v_and_b32 v99, 0xffff0000, v101
    v_pk_mul_f32 v[96:97], v[96:97], v[148:149]
    v_pk_mul_f32 v[98:99], v[98:99], v[150:151]
    v_cvt_pk_bf16_f32 v90, v96, v97
    v_cvt_pk_bf16_f32 v91, v98, v99
    buffer_store_dwordx4 v[88:91], v11, s[12:15], s52 offen sc1
    s_waitcnt lgkmcnt(0)
    v_pk_add_f32 v[112:113], v[112:113], v[124:125]
    v_pk_add_f32 v[114:115], v[114:115], v[126:127]
    v_cvt_pk_bf16_f32 v116, v112, v113
    v_cvt_pk_bf16_f32 v117, v114, v115
    v_lshlrev_b32 v112, 16, v116
    v_and_b32 v113, 0xffff0000, v116
    v_lshlrev_b32 v114, 16, v117
    v_and_b32 v115, 0xffff0000, v117
    v_pk_add_f32 v[112:113], v[112:113], v[12:13] op_sel:[0,1] op_sel_hi:[1,1]
    v_pk_add_f32 v[114:115], v[114:115], v[12:13] op_sel:[0,1] op_sel_hi:[1,1]
    v_cvt_pk_bf16_f32 v116, v112, v113
    v_cvt_pk_bf16_f32 v117, v114, v115
    v_lshlrev_b32 v112, 16, v116
    v_and_b32 v113, 0xffff0000, v116
    v_lshlrev_b32 v114, 16, v117
    v_and_b32 v115, 0xffff0000, v117
    v_pk_mul_f32 v[112:113], v[112:113], v[152:153]
    v_pk_mul_f32 v[114:115], v[114:115], v[154:155]
    v_cvt_pk_bf16_f32 v120, v112, v113
    v_cvt_pk_bf16_f32 v121, v114, v115
    buffer_store_dwordx2 v[120:121], v14, s[12:15], s56 offen sc1
    s_cmp_lg_u32 s30, 7
    s_cbranch_scc1 K2_P3
    s_waitcnt vmcnt(0)
    v_mov_b32 v3, 0
    v_mov_b32 v4, 1
    s_mov_b64 exec, 1
    buffer_store_dword v4, v3, s[12:15], s42 offen sc1
    s_mov_b64 exec, -1
    s_endpgm
K2_P3:
    s_lshl_b32 s44, s28, 11
    v_mov_b32 v2, v15
    s_lshl_b32 s43, s29, 10
    s_add_u32 s43, s43, 18087936
    v_and_b32 v5, 3, v1
    v_lshlrev_b32 v5, 2, v5
    v_bfe_u32 v9, v1, 2, 3
    v_lshl_add_u32 v5, v9, 7, v5
    s_cmp_lt_u32 s30, 6
    s_cselect_b32 s48, 1, 0
    v_and_b32 v9, 15, v1
    v_lshrrev_b32 v9, s48, v9
    v_lshlrev_b32 v9, 7, v9
    s_lshr_b32 s49, s44, s48
    s_lshl_b32 s45, s30, 12
    s_add_u32 s45, s45, s49
    s_lshr_b32 s49, s29, 3
    s_lshl_b32 s49, s49, 2
    s_add_u32 s45, s45, s49
    s_add_u32 s45, s45, 18120704
    buffer_load_dword v10, v9, s[12:15], s45 offen sc1
    s_barrier
    v_lshrrev_b32 v12, 3, v1
    v_lshlrev_b32 v12, 12, v12
    v_and_b32 v13, 7, v1
    v_lshl_add_u32 v12, v13, 4, v12
    s_lshl_b32 s47, s30, 2
    s_add_u32 s47, s47, s28
    s_lshl_b32 s47, s47, 16
    s_lshl_b32 s49, s29, 7
    s_add_u32 s47, s47, s49
    s_add_u32 s47, s47, 14680064
    s_add_u32 s49, s47, 32768
    s_waitcnt vmcnt(1)
    v_mov_b32 v3, 0
    v_mov_b32 v4, 1
    s_mov_b64 exec, 1
    buffer_store_dword v4, v3, s[12:15], s42 offen sc1
    s_mov_b64 exec, -1
    s_waitcnt vmcnt(1)
    v_cmp_eq_u32 vcc, 0, v10
    s_nop 0
    s_mov_b64 s[40:41], vcc
    s_cbranch_vccnz K2G_NOY
    s_add_u32 m0, s44, 65536
    s_nop 0
    buffer_load_dwordx4 v12, s[12:15], s47 offen sc1 lds
    s_add_u32 m0, s44, 66560
    s_nop 0
    buffer_load_dwordx4 v12, s[12:15], s49 offen sc1 lds
K2G_NOY:
    s_add_u32 m0, s31, 0
    s_add_u32 s48, s88, 4096
    buffer_load_dwordx4 v6, s[12:15], s48 offen lds
    s_add_u32 m0, s31, 1024
    s_add_u32 s48, s89, 4096
    buffer_load_dwordx4 v6, s[12:15], s48 offen lds
    s_add_u32 m0, s31, 2048
    s_add_u32 s48, s90, 4096
    buffer_load_dwordx4 v6, s[12:15], s48 offen lds
    s_add_u32 m0, s31, 3072
    s_add_u32 s48, s91, 4096
    buffer_load_dwordx4 v6, s[12:15], s48 offen lds
    s_add_u32 m0, s31, 4096
    s_add_u32 s48, s88, 5120
    buffer_load_dwordx4 v6, s[12:15], s48 offen lds
    s_add_u32 m0, s31, 5120
    s_add_u32 s48, s89, 5120
    buffer_load_dwordx4 v6, s[12:15], s48 offen lds
    s_add_u32 m0, s31, 6144
    s_add_u32 s48, s90, 5120
    buffer_load_dwordx4 v6, s[12:15], s48 offen lds
    s_add_u32 m0, s31, 7168
    s_add_u32 s48, s91, 5120
    buffer_load_dwordx4 v6, s[12:15], s48 offen lds
    s_add_u32 m0, s31, 8192
    s_add_u32 s48, s88, 6144
    buffer_load_dwordx4 v6, s[12:15], s48 offen lds
    s_add_u32 m0, s31, 9216
    s_add_u32 s48, s89, 6144
    buffer_load_dwordx4 v6, s[12:15], s48 offen lds
    s_add_u32 m0, s31, 10240
    s_add_u32 s48, s90, 6144
    buffer_load_dwordx4 v6, s[12:15], s48 offen lds
    s_add_u32 m0, s31, 11264
    s_add_u32 s48, s91, 6144
    buffer_load_dwordx4 v6, s[12:15], s48 offen lds
    v_lshlrev_b32 v4, 3, v1
    s_waitcnt lgkmcnt(0)
    s_cmp_lg_u32 s28, 0
    s_cbranch_scc1 K2G_PH_D
    s_mov_b32 s46, 20000
K2G_PH:
    buffer_load_dword v10, v5, s[12:15], s43 offen sc1
    s_waitcnt vmcnt(0)
K2G_PH_C:
    v_cmp_eq_u32 vcc, 0, v10
    s_cbranch_vccz K2G_PH_D
    s_sleep 1
    s_sub_u32 s46, s46, 1
    s_cbranch_scc0 K2G_PH
K2G_PH_D:
    s_waitcnt vmcnt(0)
    s_barrier
    buffer_load_dwordx4 v[80:83], v6, s[12:15], s92 offen offset:0 sc1
    buffer_load_dwordx4 v[84:87], v6, s[12:15], s93 offen offset:0 sc1
    buffer_load_dwordx4 v[88:91], v6, s[12:15], s94 offen offset:0 sc1
    buffer_load_dwordx4 v[92:95], v6, s[12:15], s95 offen offset:0 sc1
    buffer_load_dwordx4 v[96:99], v6, s[12:15], s92 offen offset:1024 sc1
    buffer_load_dwordx4 v[100:103], v6, s[12:15], s93 offen offset:1024 sc1
    buffer_load_dwordx4 v[104:107], v6, s[12:15], s94 offen offset:1024 sc1
    buffer_load_dwordx4 v[108:111], v6, s[12:15], s95 offen offset:1024 sc1
    v_xor_b32 v13, 16384, v8
    v_xor_b32 v14, 32768, v8
    v_xor_b32 v15, 49152, v8
    v_lshrrev_b32 v3, 4, v1
    v_bfe_u32 v11, v1, 2, 2
    v_lshl_add_u32 v11, v3, 3, v11
    v_lshlrev_b32 v11, 7, v11
    v_and_b32 v3, 3, v1
    v_lshl_add_u32 v11, v3, 3, v11
    s_lshl_b32 s48, s28, 5
    s_add_u32 s48, s48, 65536
    v_add_u32 v11, s48, v11
    s_lshl_b32 s48, s28, 11
    v_add_u32 v3, s48, v6
    v_add_u32 v3, 73728, v3
    s_waitcnt vmcnt(7)
    v_mfma_f32_16x16x32_bf16 v[16:19], v[172:175], v[80:83], 0
    v_mfma_f32_16x16x32_bf16 v[20:23], v[176:179], v[80:83], 0
    v_mfma_f32_16x16x32_bf16 v[24:27], v[180:183], v[80:83], 0
    v_mfma_f32_16x16x32_bf16 v[28:31], v[244:247], v[80:83], 0
    buffer_load_dwordx4 v[112:115], v6, s[12:15], s92 offen offset:2048 sc1
    s_waitcnt vmcnt(7)
    v_mfma_f32_16x16x32_bf16 v[32:35], v[172:175], v[84:87], 0
    v_mfma_f32_16x16x32_bf16 v[36:39], v[176:179], v[84:87], 0
    v_mfma_f32_16x16x32_bf16 v[40:43], v[180:183], v[84:87], 0
    v_mfma_f32_16x16x32_bf16 v[44:47], v[244:247], v[84:87], 0
    buffer_load_dwordx4 v[116:119], v6, s[12:15], s93 offen offset:2048 sc1
    s_waitcnt vmcnt(7)
    v_mfma_f32_16x16x32_bf16 v[48:51], v[172:175], v[88:91], 0
    v_mfma_f32_16x16x32_bf16 v[52:55], v[176:179], v[88:91], 0
    v_mfma_f32_16x16x32_bf16 v[56:59], v[180:183], v[88:91], 0
    v_mfma_f32_16x16x32_bf16 v[60:63], v[244:247], v[88:91], 0
    buffer_load_dwordx4 v[120:123], v6, s[12:15], s94 offen offset:2048 sc1
    s_waitcnt vmcnt(7)
    v_mfma_f32_16x16x32_bf16 v[64:67], v[172:175], v[92:95], 0
    v_mfma_f32_16x16x32_bf16 v[68:71], v[176:179], v[92:95], 0
    v_mfma_f32_16x16x32_bf16 v[72:75], v[180:183], v[92:95], 0
    v_mfma_f32_16x16x32_bf16 v[76:79], v[244:247], v[92:95], 0
    buffer_load_dwordx4 v[124:127], v6, s[12:15], s95 offen offset:2048 sc1
    ds_read_b128 v[172:175], v8 offset:0
    ds_read_b128 v[176:179], v8 offset:1024
    ds_read_b128 v[180:183], v8 offset:2048
    ds_read_b128 v[244:247], v8 offset:3072
    s_waitcnt vmcnt(7)
    v_mfma_f32_16x16x32_bf16 v[16:19], v[248:251], v[96:99], v[16:19]
    v_mfma_f32_16x16x32_bf16 v[20:23], v[252:255], v[96:99], v[20:23]
    v_mfma_f32_16x16x32_bf16 v[24:27], v[184:187], v[96:99], v[24:27]
    v_mfma_f32_16x16x32_bf16 v[28:31], v[188:191], v[96:99], v[28:31]
    buffer_load_dwordx2 v[156:157], v4, s[12:15], s92 offen offset:3072 sc1
    buffer_load_dwordx2 v[158:159], v4, s[12:15], s92 offen offset:3584 sc1
    s_waitcnt vmcnt(8)
    v_mfma_f32_16x16x32_bf16 v[32:35], v[248:251], v[100:103], v[32:35]
    v_mfma_f32_16x16x32_bf16 v[36:39], v[252:255], v[100:103], v[36:39]
    v_mfma_f32_16x16x32_bf16 v[40:43], v[184:187], v[100:103], v[40:43]
    v_mfma_f32_16x16x32_bf16 v[44:47], v[188:191], v[100:103], v[44:47]
    buffer_load_dwordx2 v[160:161], v4, s[12:15], s93 offen offset:3072 sc1
    buffer_load_dwordx2 v[162:163], v4, s[12:15], s93 offen offset:3584 sc1
    s_waitcnt vmcnt(9)
    v_mfma_f32_16x16x32_bf16 v[48:51], v[248:251], v[104:107], v[48:51]
    v_mfma_f32_16x16x32_bf16 v[52:55], v[252:255], v[104:107], v[52:55]
    v_mfma_f32_16x16x32_bf16 v[56:59], v[184:187], v[104:107], v[56:59]
    v_mfma_f32_16x16x32_bf16 v[60:63], v[188:191], v[104:107], v[60:63]
    buffer_load_dwordx2 v[164:165], v4, s[12:15], s94 offen offset:3072 sc1
    buffer_load_dwordx2 v[166:167], v4, s[12:15], s94 offen offset:3584 sc1
    s_waitcnt vmcnt(10)
    v_mfma_f32_16x16x32_bf16 v[64:67], v[248:251], v[108:111], v[64:67]
    v_mfma_f32_16x16x32_bf16 v[68:71], v[252:255], v[108:111], v[68:71]
    v_mfma_f32_16x16x32_bf16 v[72:75], v[184:187], v[108:111], v[72:75]
    v_mfma_f32_16x16x32_bf16 v[76:79], v[188:191], v[108:111], v[76:79]
    buffer_load_dwordx2 v[168:169], v4, s[12:15], s95 offen offset:3072 sc1
    buffer_load_dwordx2 v[170:171], v4, s[12:15], s95 offen offset:3584 sc1
    ds_read_b128 v[248:251], v8 offset:4096
    ds_read_b128 v[252:255], v8 offset:5120
    ds_read_b128 v[184:187], v8 offset:6144
    ds_read_b128 v[188:191], v8 offset:7168
    s_waitcnt vmcnt(11)
    v_mfma_f32_16x16x32_bf16 v[16:19], v[192:195], v[112:115], v[16:19]
    v_mfma_f32_16x16x32_bf16 v[20:23], v[196:199], v[112:115], v[20:23]
    v_mfma_f32_16x16x32_bf16 v[24:27], v[200:203], v[112:115], v[24:27]
    v_mfma_f32_16x16x32_bf16 v[28:31], v[204:207], v[112:115], v[28:31]
    buffer_load_dwordx4 v[240:243], v7, s[12:15], s92 offen offset:0 sc1
    s_waitcnt vmcnt(11)
    v_mfma_f32_16x16x32_bf16 v[32:35], v[192:195], v[116:119], v[32:35]
    v_mfma_f32_16x16x32_bf16 v[36:39], v[196:199], v[116:119], v[36:39]
    v_mfma_f32_16x16x32_bf16 v[40:43], v[200:203], v[116:119], v[40:43]
    v_mfma_f32_16x16x32_bf16 v[44:47], v[204:207], v[116:119], v[44:47]
    buffer_load_dwordx4 v[236:239], v7, s[12:15], s93 offen offset:0 sc1
    s_waitcnt vmcnt(11)
    v_mfma_f32_16x16x32_bf16 v[48:51], v[192:195], v[120:123], v[48:51]
    v_mfma_f32_16x16x32_bf16 v[52:55], v[196:199], v[120:123], v[52:55]
    v_mfma_f32_16x16x32_bf16 v[56:59], v[200:203], v[120:123], v[56:59]
    v_mfma_f32_16x16x32_bf16 v[60:63], v[204:207], v[120:123], v[60:63]
    buffer_load_dwordx4 v[232:235], v7, s[12:15], s94 offen offset:0 sc1
    s_waitcnt vmcnt(11)
    v_mfma_f32_16x16x32_bf16 v[64:67], v[192:195], v[124:127], v[64:67]
    v_mfma_f32_16x16x32_bf16 v[68:71], v[196:199], v[124:127], v[68:71]
    v_mfma_f32_16x16x32_bf16 v[72:75], v[200:203], v[124:127], v[72:75]
    v_mfma_f32_16x16x32_bf16 v[76:79], v[204:207], v[124:127], v[76:79]
    buffer_load_dwordx4 v[228:231], v7, s[12:15], s95 offen offset:0 sc1
    ds_read_b128 v[192:195], v8 offset:8192
    ds_read_b128 v[196:199], v8 offset:9216
    ds_read_b128 v[200:203], v8 offset:10240
    ds_read_b128 v[204:207], v8 offset:11264
    s_waitcnt vmcnt(10)
    v_mfma_f32_16x16x32_bf16 v[16:19], v[208:211], v[156:159], v[16:19]
    v_mfma_f32_16x16x32_bf16 v[20:23], v[212:215], v[156:159], v[20:23]
    v_mfma_f32_16x16x32_bf16 v[24:27], v[216:219], v[156:159], v[24:27]
    v_mfma_f32_16x16x32_bf16 v[28:31], v[220:223], v[156:159], v[28:31]
    buffer_load_dwordx4 v[152:155], v7, s[12:15], s92 offen offset:1024 sc1
    s_waitcnt vmcnt(9)
    v_mfma_f32_16x16x32_bf16 v[32:35], v[208:211], v[160:163], v[32:35]
    v_mfma_f32_16x16x32_bf16 v[36:39], v[212:215], v[160:163], v[36:39]
    v_mfma_f32_16x16x32_bf16 v[40:43], v[216:219], v[160:163], v[40:43]
    v_mfma_f32_16x16x32_bf16 v[44:47], v[220:223], v[160:163], v[44:47]
    buffer_load_dwordx4 v[148:151], v7, s[12:15], s93 offen offset:1024 sc1
    s_waitcnt vmcnt(8)
    v_mfma_f32_16x16x32_bf16 v[48:51], v[208:211], v[164:167], v[48:51]
    v_mfma_f32_16x16x32_bf16 v[52:55], v[212:215], v[164:167], v[52:55]
    v_mfma_f32_16x16x32_bf16 v[56:59], v[216:219], v[164:167], v[56:59]
    v_mfma_f32_16x16x32_bf16 v[60:63], v[220:223], v[164:167], v[60:63]
    buffer_load_dwordx4 v[144:147], v7, s[12:15], s94 offen offset:1024 sc1
    s_waitcnt vmcnt(7)
    v_mfma_f32_16x16x32_bf16 v[64:67], v[208:211], v[168:171], v[64:67]
    v_mfma_f32_16x16x32_bf16 v[68:71], v[212:215], v[168:171], v[68:71]
    v_mfma_f32_16x16x32_bf16 v[72:75], v[216:219], v[168:171], v[72:75]
    v_mfma_f32_16x16x32_bf16 v[76:79], v[220:223], v[168:171], v[76:79]
    buffer_load_dwordx4 v[140:143], v7, s[12:15], s95 offen offset:1024 sc1
    s_waitcnt lgkmcnt(8)
    s_waitcnt vmcnt(7)
    v_mfma_f32_16x16x32_bf16 v[16:19], v[172:175], v[240:243], v[16:19]
    v_mfma_f32_16x16x32_bf16 v[20:23], v[176:179], v[240:243], v[20:23]
    v_mfma_f32_16x16x32_bf16 v[24:27], v[180:183], v[240:243], v[24:27]
    v_mfma_f32_16x16x32_bf16 v[28:31], v[244:247], v[240:243], v[28:31]
    buffer_load_dword v10, v9, s[12:15], s45 offen sc1
    buffer_load_dwordx4 v[132:135], v7, s[12:15], s93 offen offset:2048 sc1
    s_waitcnt vmcnt(8)
    v_mfma_f32_16x16x32_bf16 v[32:35], v[172:175], v[236:239], v[32:35]
    v_mfma_f32_16x16x32_bf16 v[36:39], v[176:179], v[236:239], v[36:39]
    v_mfma_f32_16x16x32_bf16 v[40:43], v[180:183], v[236:239], v[40:43]
    v_mfma_f32_16x16x32_bf16 v[44:47], v[244:247], v[236:239], v[44:47]
    buffer_load_dwordx4 v[128:131], v7, s[12:15], s94 offen offset:2048 sc1
    s_waitcnt vmcnt(8)
    v_mfma_f32_16x16x32_bf16 v[48:51], v[172:175], v[232:235], v[48:51]
    v_mfma_f32_16x16x32_bf16 v[52:55], v[176:179], v[232:235], v[52:55]
    v_mfma_f32_16x16x32_bf16 v[56:59], v[180:183], v[232:235], v[56:59]
    v_mfma_f32_16x16x32_bf16 v[60:63], v[244:247], v[232:235], v[60:63]
    buffer_load_dwordx4 v[224:227], v7, s[12:15], s95 offen offset:2048 sc1
    s_waitcnt vmcnt(8)
    v_mfma_f32_16x16x32_bf16 v[64:67], v[172:175], v[228:231], v[64:67]
    v_mfma_f32_16x16x32_bf16 v[68:71], v[176:179], v[228:231], v[68:71]
    v_mfma_f32_16x16x32_bf16 v[72:75], v[180:183], v[228:231], v[72:75]
    v_mfma_f32_16x16x32_bf16 v[76:79], v[244:247], v[228:231], v[76:79]
    buffer_load_dwordx4 v[136:139], v7, s[12:15], s92 offen offset:2048 sc1
    s_waitcnt lgkmcnt(4)
    s_waitcnt vmcnt(8)
    v_mfma_f32_16x16x32_bf16 v[16:19], v[248:251], v[152:155], v[16:19]
    v_mfma_f32_16x16x32_bf16 v[20:23], v[252:255], v[152:155], v[20:23]
    v_mfma_f32_16x16x32_bf16 v[24:27], v[184:187], v[152:155], v[24:27]
    v_mfma_f32_16x16x32_bf16 v[28:31], v[188:191], v[152:155], v[28:31]
    s_waitcnt vmcnt(7)
    v_mfma_f32_16x16x32_bf16 v[32:35], v[248:251], v[148:151], v[32:35]
    v_mfma_f32_16x16x32_bf16 v[36:39], v[252:255], v[148:151], v[36:39]
    v_mfma_f32_16x16x32_bf16 v[40:43], v[184:187], v[148:151], v[40:43]
    v_mfma_f32_16x16x32_bf16 v[44:47], v[188:191], v[148:151], v[44:47]
    s_waitcnt vmcnt(6)
    v_mfma_f32_16x16x32_bf16 v[48:51], v[248:251], v[144:147], v[48:51]
    v_mfma_f32_16x16x32_bf16 v[52:55], v[252:255], v[144:147], v[52:55]
    v_mfma_f32_16x16x32_bf16 v[56:59], v[184:187], v[144:147], v[56:59]
    v_mfma_f32_16x16x32_bf16 v[60:63], v[188:191], v[144:147], v[60:63]
    s_waitcnt vmcnt(5)
    v_mfma_f32_16x16x32_bf16 v[64:67], v[248:251], v[140:143], v[64:67]
    v_mfma_f32_16x16x32_bf16 v[68:71], v[252:255], v[140:143], v[68:71]
    v_mfma_f32_16x16x32_bf16 v[72:75], v[184:187], v[140:143], v[72:75]
    v_mfma_f32_16x16x32_bf16 v[76:79], v[188:191], v[140:143], v[76:79]
    s_waitcnt lgkmcnt(0)
    s_waitcnt vmcnt(4)
    s_cmp_eq_u64 s[40:41], 0
    s_cbranch_scc1 K2G_NOY2
    v_cmp_eq_u32 vcc, 0, v10
    s_nop 0
    s_mov_b64 s[40:41], vcc
    s_cbranch_vccnz K2G_NOY2
    s_add_u32 m0, s44, 65536
    s_nop 0
    buffer_load_dwordx4 v12, s[12:15], s47 offen sc1 lds
    s_add_u32 m0, s44, 66560
    s_nop 0
    buffer_load_dwordx4 v12, s[12:15], s49 offen sc1 lds
    s_waitcnt vmcnt(2)
K2G_NOY2:
    s_waitcnt vmcnt(3)
    v_mfma_f32_16x16x32_bf16 v[32:35], v[192:195], v[132:135], v[32:35]
    v_mfma_f32_16x16x32_bf16 v[36:39], v[196:199], v[132:135], v[36:39]
    v_mfma_f32_16x16x32_bf16 v[40:43], v[200:203], v[132:135], v[40:43]
    v_mfma_f32_16x16x32_bf16 v[44:47], v[204:207], v[132:135], v[44:47]
    s_waitcnt vmcnt(2)
    v_mfma_f32_16x16x32_bf16 v[48:51], v[192:195], v[128:131], v[48:51]
    v_mfma_f32_16x16x32_bf16 v[52:55], v[196:199], v[128:131], v[52:55]
    v_mfma_f32_16x16x32_bf16 v[56:59], v[200:203], v[128:131], v[56:59]
    v_mfma_f32_16x16x32_bf16 v[60:63], v[204:207], v[128:131], v[60:63]
    ds_write_b128 v8, v[32:35] offset:0
    ds_write_b128 v8, v[36:39] offset:1024
    ds_write_b128 v8, v[40:43] offset:2048
    ds_write_b128 v8, v[44:47] offset:3072
    s_waitcnt vmcnt(1)
    v_mfma_f32_16x16x32_bf16 v[64:67], v[192:195], v[224:227], v[64:67]
    v_mfma_f32_16x16x32_bf16 v[68:71], v[196:199], v[224:227], v[68:71]
    v_mfma_f32_16x16x32_bf16 v[72:75], v[200:203], v[224:227], v[72:75]
    v_mfma_f32_16x16x32_bf16 v[76:79], v[204:207], v[224:227], v[76:79]
    ds_write_b128 v8, v[48:51] offset:4096
    ds_write_b128 v8, v[52:55] offset:5120
    ds_write_b128 v8, v[56:59] offset:6144
    ds_write_b128 v8, v[60:63] offset:7168
    s_waitcnt vmcnt(0)
    v_mfma_f32_16x16x32_bf16 v[16:19], v[192:195], v[136:139], v[16:19]
    v_mfma_f32_16x16x32_bf16 v[20:23], v[196:199], v[136:139], v[20:23]
    v_mfma_f32_16x16x32_bf16 v[24:27], v[200:203], v[136:139], v[24:27]
    v_mfma_f32_16x16x32_bf16 v[28:31], v[204:207], v[136:139], v[28:31]
    ds_write_b128 v8, v[64:67] offset:8192
    ds_write_b128 v8, v[68:71] offset:9216
    ds_write_b128 v8, v[72:75] offset:10240
    ds_write_b128 v8, v[76:79] offset:11264
    s_cmp_eq_u64 s[40:41], 0
    s_cbranch_scc1 K2G_YOK
    s_mov_b32 s46, 20000
K2G_PY:
    buffer_load_dword v10, v9, s[12:15], s45 offen sc1
    s_waitcnt vmcnt(0)
K2G_PY_C:
    v_cmp_eq_u32 vcc, 0, v10
    s_cbranch_vccz K2G_PY_D
    s_sleep 2
    s_sub_u32 s46, s46, 1
    s_cbranch_scc0 K2G_PY
K2G_PY_D:
    s_add_u32 m0, s44, 65536
    s_nop 0
    buffer_load_dwordx4 v12, s[12:15], s47 offen sc1 lds
    s_add_u32 m0, s44, 66560
    s_nop 0
    buffer_load_dwordx4 v12, s[12:15], s49 offen sc1 lds
K2G_YOK:
    ds_read_b128 v[128:131], v3 offset:0
    ds_read_b128 v[132:135], v3 offset:1024
    s_waitcnt vmcnt(0) lgkmcnt(0)
    s_barrier
    ds_read_b64_tr_b16 v[136:137], v11 offset:0
    ds_read_b64_tr_b16 v[138:139], v11 offset:512
    ds_read_b64_tr_b16 v[140:141], v11 offset:4096
    ds_read_b64_tr_b16 v[142:143], v11 offset:4608
    ds_read_b128 v[80:83], v13 offset:0
    ds_read_b128 v[96:99], v14 offset:4096
    ds_read_b128 v[112:115], v15 offset:8192
    ds_read_b128 v[84:87], v13 offset:1024
    ds_read_b128 v[100:103], v14 offset:5120
    ds_read_b128 v[116:119], v15 offset:9216
    ds_read_b128 v[88:91], v13 offset:2048
    ds_read_b128 v[104:107], v14 offset:6144
    ds_read_b128 v[120:123], v15 offset:10240
    ds_read_b128 v[92:95], v13 offset:3072
    ds_read_b128 v[108:111], v14 offset:7168
    ds_read_b128 v[124:127], v15 offset:11264
    v_lshlrev_b32 v144, 16, v128
    v_and_b32 v145, 0xffff0000, v128
    v_lshlrev_b32 v146, 16, v129
    v_and_b32 v147, 0xffff0000, v129
    v_lshlrev_b32 v148, 16, v130
    v_and_b32 v149, 0xffff0000, v130
    v_lshlrev_b32 v150, 16, v131
    v_and_b32 v151, 0xffff0000, v131
    v_lshlrev_b32 v152, 16, v132
    v_and_b32 v153, 0xffff0000, v132
    v_lshlrev_b32 v154, 16, v133
    v_and_b32 v155, 0xffff0000, v133
    v_lshlrev_b32 v156, 16, v134
    v_and_b32 v157, 0xffff0000, v134
    v_lshlrev_b32 v158, 16, v135
    v_and_b32 v159, 0xffff0000, v135
    s_waitcnt lgkmcnt(12)
    v_lshlrev_b32 v160, 16, v136
    v_and_b32 v161, 0xffff0000, v136
    v_lshlrev_b32 v162, 16, v137
    v_and_b32 v163, 0xffff0000, v137
    v_lshlrev_b32 v164, 16, v138
    v_and_b32 v165, 0xffff0000, v138
    v_lshlrev_b32 v166, 16, v139
    v_and_b32 v167, 0xffff0000, v139
    v_lshlrev_b32 v168, 16, v140
    v_and_b32 v169, 0xffff0000, v140
    v_lshlrev_b32 v170, 16, v141
    v_and_b32 v171, 0xffff0000, v141
    v_lshlrev_b32 v172, 16, v142
    v_and_b32 v173, 0xffff0000, v142
    v_lshlrev_b32 v174, 16, v143
    v_and_b32 v175, 0xffff0000, v143
    v_pk_add_f32 v[144:145], v[144:145], v[160:161]
    v_pk_add_f32 v[146:147], v[146:147], v[162:163]
    v_pk_add_f32 v[148:149], v[148:149], v[164:165]
    v_pk_add_f32 v[150:151], v[150:151], v[166:167]
    v_pk_add_f32 v[152:153], v[152:153], v[168:169]
    v_pk_add_f32 v[154:155], v[154:155], v[170:171]
    v_pk_add_f32 v[156:157], v[156:157], v[172:173]
    v_pk_add_f32 v[158:159], v[158:159], v[174:175]
    v_cvt_pk_bf16_f32 v128, v144, v145
    v_cvt_pk_bf16_f32 v129, v146, v147
    v_cvt_pk_bf16_f32 v130, v148, v149
    v_cvt_pk_bf16_f32 v131, v150, v151
    v_cvt_pk_bf16_f32 v132, v152, v153
    v_cvt_pk_bf16_f32 v133, v154, v155
    v_cvt_pk_bf16_f32 v134, v156, v157
    v_cvt_pk_bf16_f32 v135, v158, v159
    v_lshlrev_b32 v144, 16, v128
    v_and_b32 v145, 0xffff0000, v128
    v_lshlrev_b32 v146, 16, v129
    v_and_b32 v147, 0xffff0000, v129
    v_lshlrev_b32 v148, 16, v130
    v_and_b32 v149, 0xffff0000, v130
    v_lshlrev_b32 v150, 16, v131
    v_and_b32 v151, 0xffff0000, v131
    v_lshlrev_b32 v152, 16, v132
    v_and_b32 v153, 0xffff0000, v132
    v_lshlrev_b32 v154, 16, v133
    v_and_b32 v155, 0xffff0000, v133
    v_lshlrev_b32 v156, 16, v134
    v_and_b32 v157, 0xffff0000, v134
    v_lshlrev_b32 v158, 16, v135
    v_and_b32 v159, 0xffff0000, v135
    s_waitcnt lgkmcnt(9)
    v_pk_add_f32 v[16:17], v[16:17], v[80:81]
    v_pk_add_f32 v[96:97], v[96:97], v[112:113]
    v_pk_add_f32 v[18:19], v[18:19], v[82:83]
    v_pk_add_f32 v[98:99], v[98:99], v[114:115]
    v_pk_add_f32 v[16:17], v[16:17], v[96:97]
    v_pk_add_f32 v[18:19], v[18:19], v[98:99]
    v_cvt_pk_bf16_f32 v80, v16, v17
    v_lshlrev_b32 v16, 16, v80
    v_and_b32 v17, 0xffff0000, v80
    v_pk_add_f32 v[16:17], v[16:17], v[144:145]
    v_cvt_pk_bf16_f32 v176, v16, v17
    v_cvt_pk_bf16_f32 v82, v18, v19
    v_lshlrev_b32 v18, 16, v82
    v_and_b32 v19, 0xffff0000, v82
    v_pk_add_f32 v[18:19], v[18:19], v[146:147]
    v_cvt_pk_bf16_f32 v177, v18, v19
    s_waitcnt lgkmcnt(6)
    v_pk_add_f32 v[20:21], v[20:21], v[84:85]
    v_pk_add_f32 v[100:101], v[100:101], v[116:117]
    v_pk_add_f32 v[22:23], v[22:23], v[86:87]
    v_pk_add_f32 v[102:103], v[102:103], v[118:119]
    v_pk_add_f32 v[20:21], v[20:21], v[100:101]
    v_pk_add_f32 v[22:23], v[22:23], v[102:103]
    v_cvt_pk_bf16_f32 v84, v20, v21
    v_lshlrev_b32 v20, 16, v84
    v_and_b32 v21, 0xffff0000, v84
    v_pk_add_f32 v[20:21], v[20:21], v[148:149]
    v_cvt_pk_bf16_f32 v178, v20, v21
    v_cvt_pk_bf16_f32 v86, v22, v23
    v_lshlrev_b32 v22, 16, v86
    v_and_b32 v23, 0xffff0000, v86
    v_pk_add_f32 v[22:23], v[22:23], v[150:151]
    v_cvt_pk_bf16_f32 v179, v22, v23
    buffer_store_dwordx4 v[176:179], v2, s[24:27], s54 offen offset:0 sc1
    s_waitcnt lgkmcnt(3)
    v_pk_add_f32 v[24:25], v[24:25], v[88:89]
    v_pk_add_f32 v[104:105], v[104:105], v[120:121]
    v_pk_add_f32 v[26:27], v[26:27], v[90:91]
    v_pk_add_f32 v[106:107], v[106:107], v[122:123]
    v_pk_add_f32 v[24:25], v[24:25], v[104:105]
    v_pk_add_f32 v[26:27], v[26:27], v[106:107]
    v_cvt_pk_bf16_f32 v88, v24, v25
    v_lshlrev_b32 v24, 16, v88
    v_and_b32 v25, 0xffff0000, v88
    v_pk_add_f32 v[24:25], v[24:25], v[152:153]
    v_cvt_pk_bf16_f32 v180, v24, v25
    v_cvt_pk_bf16_f32 v90, v26, v27
    v_lshlrev_b32 v26, 16, v90
    v_and_b32 v27, 0xffff0000, v90
    v_pk_add_f32 v[26:27], v[26:27], v[154:155]
    v_cvt_pk_bf16_f32 v181, v26, v27
    s_waitcnt lgkmcnt(0)
    v_pk_add_f32 v[28:29], v[28:29], v[92:93]
    v_pk_add_f32 v[108:109], v[108:109], v[124:125]
    v_pk_add_f32 v[30:31], v[30:31], v[94:95]
    v_pk_add_f32 v[110:111], v[110:111], v[126:127]
    v_pk_add_f32 v[28:29], v[28:29], v[108:109]
    v_pk_add_f32 v[30:31], v[30:31], v[110:111]
    v_cvt_pk_bf16_f32 v92, v28, v29
    v_lshlrev_b32 v28, 16, v92
    v_and_b32 v29, 0xffff0000, v92
    v_pk_add_f32 v[28:29], v[28:29], v[156:157]
    v_cvt_pk_bf16_f32 v182, v28, v29
    v_cvt_pk_bf16_f32 v94, v30, v31
    v_lshlrev_b32 v30, 16, v94
    v_and_b32 v31, 0xffff0000, v94
    v_pk_add_f32 v[30:31], v[30:31], v[158:159]
    v_cvt_pk_bf16_f32 v183, v30, v31
    buffer_store_dwordx4 v[180:183], v2, s[24:27], s54 offen offset:64 sc1
    s_endpgm
K2_CONV:
    s_load_dwordx2 s[12:13], s[0:1], 112
    s_load_dwordx2 s[20:21], s[0:1], 8
    s_load_dwordx2 s[24:25], s[0:1], 16
    s_load_dwordx2 s[32:33], s[0:1], 24
    s_load_dwordx2 s[36:37], s[0:1], 32
    s_load_dwordx2 s[40:41], s[0:1], 40
    s_load_dwordx2 s[44:45], s[0:1], 48
    s_mov_b32 s14, 268435456
    s_mov_b32 s15, 0x00020000
    s_mov_b32 s22, 229376
    s_mov_b32 s23, 0x00020000
    s_mov_b32 s26, 229376
    s_mov_b32 s27, 0x00020000
    s_mov_b32 s34, 229376
    s_mov_b32 s35, 0x00020000
    s_mov_b32 s38, 229376
    s_mov_b32 s39, 0x00020000
    s_mov_b32 s42, 896
    s_mov_b32 s43, 0x00020000
    s_mov_b32 s46, 896
    s_mov_b32 s47, 0x00020000
    s_sub_u32 s29, s2, 256
    s_mov_b32 s52, 0
    s_add_u32 s48, s29, 192
    s_lshl_b32 s29, s29, 1
    s_cmp_ge_u32 s29, 384
    s_cselect_b32 s29, s48, s29
    s_cselect_b32 s52, 1, 0
    v_lshlrev_b32 v2, 1, v0
    s_lshl_b32 s30, s29, 9
    s_lshl_b32 s31, s29, 1
    v_mov_b32 v3, 0
    v_lshlrev_b32 v4, 4, v1
    s_mul_i32 s48, s29, 4096
    s_lshl_b32 s51, s28, 10
    s_add_u32 s50, s48, s51
    s_add_u32 s50, s50, 12582912
    s_add_u32 s51, s51, 62016
    s_mov_b32 m0, s51
    s_mov_b32 s53, 62016
    s_waitcnt lgkmcnt(0)
    buffer_load_ushort v9, v3, s[40:43], s31 offen
    buffer_load_ushort v5, v2, s[20:23], s30 offen
    buffer_load_ushort v6, v2, s[24:27], s30 offen
    buffer_load_ushort v7, v2, s[32:35], s30 offen
    buffer_load_ushort v8, v2, s[36:39], s30 offen
    buffer_load_ushort v10, v3, s[44:47], s31 offen
    buffer_load_ushort v205, v3, s[44:47], s31 offen offset:2
    buffer_load_dwordx4 v4, s[12:15], s50 offen lds
    s_lshl_b32 s48, s29, 11
    s_lshl_b32 s49, s28, 10
    s_add_u32 s48, s48, s49
    s_add_u32 s48, s48, 20971520
    s_add_u32 s50, s50, 4096
    s_mov_b32 s54, s52
    buffer_load_dwordx4 v[206:209], v4, s[12:15], s48 offen
    buffer_load_dwordx4 v[210:213], v4, s[12:15], s50 offen
    v_mov_b32 v12, 0
    v_mov_b32 v13, 0
    v_lshlrev_b32 v11, 3, v1
    v_add_u32 v14, 66112, v11
    ds_write_b64 v14, v[12:13]
    v_and_b32 v11, 24, v11
    v_add_u32 v11, 70752, v11
    ds_write_b64 v11, v[12:13]
    ds_write_b64 v11, v[12:13] offset:4160
    v_mov_b32 v11, 66632
    ds_write_b64 v11, v[12:13]
    v_lshlrev_b32 v11, 3, v0
    v_add_u32 v16, -1, v11
    v_add_u32 v17, 0, v11
    v_add_u32 v18, 1, v11
    v_add_u32 v19, 2, v11
    v_add_u32 v20, 3, v11
    v_add_u32 v21, 4, v11
    v_add_u32 v22, 5, v11
    v_add_u32 v23, 6, v11
    v_add_u32 v24, 7, v11
    v_cvt_f32_i32 v16, v16
    v_cvt_f32_i32 v17, v17
    v_cvt_f32_i32 v18, v18
    v_cvt_f32_i32 v19, v19
    v_cvt_f32_i32 v20, v20
    v_cvt_f32_i32 v21, v21
    v_cvt_f32_i32 v22, v22
    v_cvt_f32_i32 v23, v23
    v_cvt_f32_i32 v24, v24
    v_cvt_pk_bf16_f32 v16, v16, v16
    v_lshlrev_b32 v16, 16, v16
    v_cvt_pk_bf16_f32 v17, v17, v17
    v_lshlrev_b32 v17, 16, v17
    v_cvt_pk_bf16_f32 v18, v18, v18
    v_lshlrev_b32 v18, 16, v18
    v_cvt_pk_bf16_f32 v19, v19, v19
    v_lshlrev_b32 v19, 16, v19
    v_cvt_pk_bf16_f32 v20, v20, v20
    v_lshlrev_b32 v20, 16, v20
    v_cvt_pk_bf16_f32 v21, v21, v21
    v_lshlrev_b32 v21, 16, v21
    v_cvt_pk_bf16_f32 v22, v22, v22
    v_lshlrev_b32 v22, 16, v22
    v_cvt_pk_bf16_f32 v23, v23, v23
    v_lshlrev_b32 v23, 16, v23
    v_cvt_pk_bf16_f32 v24, v24, v24
    v_lshlrev_b32 v24, 16, v24
    v_cvt_i32_f32 v16, v16
    v_cvt_i32_f32 v17, v17
    v_cvt_i32_f32 v18, v18
    v_cvt_i32_f32 v19, v19
    v_cvt_i32_f32 v20, v20
    v_cvt_i32_f32 v21, v21
    v_cvt_i32_f32 v22, v22
    v_cvt_i32_f32 v23, v23
    v_cvt_i32_f32 v24, v24
    v_min_i32 v16, 2047, v16
    v_min_i32 v17, 2047, v17
    v_min_i32 v18, 2047, v18
    v_min_i32 v19, 2047, v19
    v_min_i32 v20, 2047, v20
    v_min_i32 v21, 2047, v21
    v_min_i32 v22, 2047, v22
    v_min_i32 v23, 2047, v23
    v_min_i32 v24, 2047, v24
    v_mov_b32 v11, 66640
    v_lshl_add_u32 v16, v16, 1, v11
    v_lshl_add_u32 v17, v17, 1, v11
    v_lshl_add_u32 v18, v18, 1, v11
    v_lshl_add_u32 v19, v19, 1, v11
    v_lshl_add_u32 v20, v20, 1, v11
    v_lshl_add_u32 v21, v21, 1, v11
    v_lshl_add_u32 v22, v22, 1, v11
    v_lshl_add_u32 v23, v23, 1, v11
    v_lshl_add_u32 v24, v24, 1, v11
    v_and_b32 v25, 15, v1
    v_lshrrev_b32 v26, 4, v1
    s_waitcnt vmcnt(3)
    v_lshlrev_b32 v205, 16, v205
    v_lshlrev_b32 v9, 16, v9
    v_lshlrev_b32 v10, 16, v10
    v_lshlrev_b32 v5, 16, v5
    v_mul_f32 v12, 0x3fb8aa3b, v9
    v_mov_b32 v14, 0x3fb8aa3b
    v_fma_f32 v13, v9, v14, -v12
    v_fmac_f32 v13, 0x32a57060, v9
    v_exp_f32 v12, v12
    v_mul_f32 v13, 0x3f317218, v13
    v_fma_f32 v9, v12, v13, v12
    v_cvt_pk_bf16_f32 v9, v9, v9
    v_lshlrev_b32 v9, 16, v9
    v_mul_f32 v12, 0x3fb8aa3b, v5
    v_mov_b32 v14, 0x3fb8aa3b
    v_fma_f32 v13, v5, v14, -v12
    v_fmac_f32 v13, 0x32a57060, v5
    v_exp_f32 v12, v12
    v_mul_f32 v13, 0x3f317218, v13
    v_fma_f32 v5, v12, v13, v12
    v_cvt_pk_bf16_f32 v5, v5, v5
    v_lshlrev_b32 v5, 16, v5
    v_lshlrev_b32 v6, 16, v6
    v_lshlrev_b32 v7, 16, v7
    v_lshlrev_b32 v8, 16, v8
    v_mul_f32 v5, -v5, v9
    v_mul_f32 v6, v6, v9
    v_mul_f32 v66, v7, v9
    v_mul_f32 v67, v8, v9
    v_mul_f32 v66, 0x42800000, v66
    v_mul_f32 v67, 0x42800000, v67
    v_mul_f32 v27, 0x3fb8aa3b, v5
    v_mul_f32 v35, 0x3e22f983, v6
    v_exp_f32 v27, v27
    v_cos_f32 v34, v35
    v_sin_f32 v35, v35
    v_mul_f32 v28, 0x4138aa3b, v5
    v_mul_f32 v51, 0x3fa2f983, v6
    v_exp_f32 v28, v28
    v_cos_f32 v50, v51
    v_sin_f32 v51, v51
    v_mul_f32 v29, 0x4338aa3b, v5
    v_mul_f32 v85, 0x41a2f983, v6
    v_exp_f32 v29, v29
    v_cos_f32 v84, v85
    v_sin_f32 v85, v85
    v_mul_f32 v34, v34, v27
    v_mul_f32 v35, v35, v27
    v_mul_f32 v50, v50, v28
    v_mul_f32 v51, v51, v28
    v_mul_f32 v84, v84, v29
    v_mul_f32 v85, v85, v29
    s_mul_i32 s48, s28, 15504
    v_lshlrev_b32 v11, 2, v1
    v_add_u32 v11, s48, v11
    v_mul_f32 v36, v34, v34
    v_add_f32 v37, v34, v34
    v_mul_f32 v52, v50, v50
    v_add_f32 v53, v50, v50
    v_mul_f32 v86, v84, v84
    v_add_f32 v87, v84, v84
    v_fma_f32 v36, -v35, v35, v36
    v_mul_f32 v37, v37, v35
    v_fma_f32 v52, -v51, v51, v52
    v_mul_f32 v53, v53, v51
    v_fma_f32 v86, -v85, v85, v86
    v_mul_f32 v87, v87, v85
    v_mov_b32 v30, 0x3c00
    ds_write_b32 v11, v30 offset:11152
    v_cvt_pk_f16_f32 v120, v66, -v67
    ds_write_b32 v11, v120 offset:0
    v_cvt_pk_f16_f32 v105, v50, v51
    ds_write_b32 v11, v105 offset:11424
    v_cvt_pk_f16_f32 v97, v34, -v35
    v_cvt_pk_f16_f32 v180, v84, -v85
    v_mul_f32 v40, v36, v36
    v_add_f32 v41, v36, v36
    v_mul_f32 v56, v52, v52
    v_add_f32 v57, v52, v52
    v_mul_f32 v88, v86, v86
    v_add_f32 v89, v86, v86
    v_fma_f32 v40, -v37, v37, v40
    v_mul_f32 v41, v41, v37
    v_fma_f32 v56, -v53, v53, v56
    v_mul_f32 v57, v57, v53
    v_fma_f32 v88, -v87, v87, v88
    v_mul_f32 v89, v89, v87
    v_cvt_pk_f16_f32 v106, v52, v53
    ds_write_b32 v11, v106 offset:11696
    v_cvt_pk_f16_f32 v98, v36, -v37
    v_cvt_pk_f16_f32 v181, v86, -v87
    v_mul_f32 v64, v56, v56
    v_add_f32 v65, v56, v56
    v_mul_f32 v90, v88, v88
    v_add_f32 v91, v88, v88
    v_fma_f32 v64, -v57, v57, v64
    v_mul_f32 v65, v65, v57
    v_fma_f32 v90, -v89, v89, v90
    v_mul_f32 v91, v91, v89
    v_cvt_pk_f16_f32 v108, v56, v57
    ds_write_b32 v11, v108 offset:12240
    v_cvt_pk_f16_f32 v100, v40, -v41
    v_cvt_pk_f16_f32 v182, v88, -v89
    v_pk_mul_f16 v121, v120, v180 op_sel:[0,0] op_sel_hi:[1,0]
    v_pk_mul_f16 v122, v120, v181 op_sel:[0,0] op_sel_hi:[1,0]
    v_pk_mul_f16 v99, v98, v97 op_sel:[0,0] op_sel_hi:[1,0]
    v_pk_mul_f16 v107, v106, v105 op_sel:[0,0] op_sel_hi:[1,0]
    v_pk_mul_f16 v124, v120, v182 op_sel:[0,0] op_sel_hi:[1,0]
    v_pk_mul_f16 v101, v100, v97 op_sel:[0,0] op_sel_hi:[1,0]
    v_pk_mul_f16 v102, v100, v98 op_sel:[0,0] op_sel_hi:[1,0]
    v_pk_mul_f16 v109, v108, v105 op_sel:[0,0] op_sel_hi:[1,0]
    v_pk_mul_f16 v110, v108, v106 op_sel:[0,0] op_sel_hi:[1,0]
    v_pk_fma_f16 v121, v120, v180, v121 op_sel:[1,1,0] op_sel_hi:[0,1,1] neg_lo:[1,0,0]
    v_pk_fma_f16 v122, v120, v181, v122 op_sel:[1,1,0] op_sel_hi:[0,1,1] neg_lo:[1,0,0]
    v_pk_fma_f16 v99, v98, v97, v99 op_sel:[1,1,0] op_sel_hi:[0,1,1] neg_lo:[1,0,0]
    v_pk_fma_f16 v107, v106, v105, v107 op_sel:[1,1,0] op_sel_hi:[0,1,1] neg_lo:[1,0,0]
    v_pk_fma_f16 v124, v120, v182, v124 op_sel:[1,1,0] op_sel_hi:[0,1,1] neg_lo:[1,0,0]
    v_pk_fma_f16 v101, v100, v97, v101 op_sel:[1,1,0] op_sel_hi:[0,1,1] neg_lo:[1,0,0]
    v_pk_fma_f16 v102, v100, v98, v102 op_sel:[1,1,0] op_sel_hi:[0,1,1] neg_lo:[1,0,0]
    v_pk_fma_f16 v109, v108, v105, v109 op_sel:[1,1,0] op_sel_hi:[0,1,1] neg_lo:[1,0,0]
    v_pk_fma_f16 v110, v108, v106, v110 op_sel:[1,1,0] op_sel_hi:[0,1,1] neg_lo:[1,0,0]
    ds_write_b32 v11, v121 offset:2176
    ds_write_b32 v11, v122 offset:4352
    ds_write_b32 v11, v107 offset:11968
    ds_write_b32 v11, v124 offset:6528
    ds_write_b32 v11, v109 offset:12512
    ds_write_b32 v11, v110 offset:12784
    v_cvt_pk_f16_f32 v112, v64, v65
    ds_write_b32 v11, v112 offset:13328
    v_cvt_pk_f16_f32 v138, v90, -v91
    v_pk_mul_f16 v123, v121, v181 op_sel:[0,0] op_sel_hi:[1,0]
    v_pk_mul_f16 v125, v121, v182 op_sel:[0,0] op_sel_hi:[1,0]
    v_pk_mul_f16 v126, v122, v182 op_sel:[0,0] op_sel_hi:[1,0]
    v_pk_mul_f16 v103, v100, v99 op_sel:[0,0] op_sel_hi:[1,0]
    v_pk_mul_f16 v111, v108, v107 op_sel:[0,0] op_sel_hi:[1,0]
    v_pk_mul_f16 v128, v120, v138 op_sel:[0,0] op_sel_hi:[1,0]
    v_pk_mul_f16 v129, v121, v138 op_sel:[0,0] op_sel_hi:[1,0]
    v_pk_mul_f16 v130, v122, v138 op_sel:[0,0] op_sel_hi:[1,0]
    v_pk_mul_f16 v132, v124, v138 op_sel:[0,0] op_sel_hi:[1,0]
    v_pk_mul_f16 v113, v112, v105 op_sel:[0,0] op_sel_hi:[1,0]
    v_pk_mul_f16 v114, v112, v106 op_sel:[0,0] op_sel_hi:[1,0]
    v_pk_mul_f16 v115, v112, v107 op_sel:[0,0] op_sel_hi:[1,0]
    v_pk_mul_f16 v116, v112, v108 op_sel:[0,0] op_sel_hi:[1,0]
    v_pk_mul_f16 v117, v112, v109 op_sel:[0,0] op_sel_hi:[1,0]
    v_pk_mul_f16 v118, v112, v110 op_sel:[0,0] op_sel_hi:[1,0]
    v_pk_fma_f16 v123, v121, v181, v123 op_sel:[1,1,0] op_sel_hi:[0,1,1] neg_lo:[1,0,0]
    v_pk_fma_f16 v125, v121, v182, v125 op_sel:[1,1,0] op_sel_hi:[0,1,1] neg_lo:[1,0,0]
    v_pk_fma_f16 v126, v122, v182, v126 op_sel:[1,1,0] op_sel_hi:[0,1,1] neg_lo:[1,0,0]
    v_pk_fma_f16 v103, v100, v99, v103 op_sel:[1,1,0] op_sel_hi:[0,1,1] neg_lo:[1,0,0]
    v_pk_fma_f16 v111, v108, v107, v111 op_sel:[1,1,0] op_sel_hi:[0,1,1] neg_lo:[1,0,0]
    v_pk_fma_f16 v128, v120, v138, v128 op_sel:[1,1,0] op_sel_hi:[0,1,1] neg_lo:[1,0,0]
    v_pk_fma_f16 v129, v121, v138, v129 op_sel:[1,1,0] op_sel_hi:[0,1,1] neg_lo:[1,0,0]
    v_pk_fma_f16 v130, v122, v138, v130 op_sel:[1,1,0] op_sel_hi:[0,1,1] neg_lo:[1,0,0]
    v_pk_fma_f16 v132, v124, v138, v132 op_sel:[1,1,0] op_sel_hi:[0,1,1] neg_lo:[1,0,0]
    v_pk_fma_f16 v113, v112, v105, v113 op_sel:[1,1,0] op_sel_hi:[0,1,1] neg_lo:[1,0,0]
    v_pk_fma_f16 v114, v112, v106, v114 op_sel:[1,1,0] op_sel_hi:[0,1,1] neg_lo:[1,0,0]
    v_pk_fma_f16 v115, v112, v107, v115 op_sel:[1,1,0] op_sel_hi:[0,1,1] neg_lo:[1,0,0]
    v_pk_fma_f16 v116, v112, v108, v116 op_sel:[1,1,0] op_sel_hi:[0,1,1] neg_lo:[1,0,0]
    v_pk_fma_f16 v117, v112, v109, v117 op_sel:[1,1,0] op_sel_hi:[0,1,1] neg_lo:[1,0,0]
    v_pk_fma_f16 v118, v112, v110, v118 op_sel:[1,1,0] op_sel_hi:[0,1,1] neg_lo:[1,0,0]
    ds_write_b32 v11, v123 offset:5440
    ds_write_b32 v11, v125 offset:7072
    ds_write_b32 v11, v126 offset:7616
    ds_write_b32 v11, v111 offset:13056
    ds_write_b32 v11, v128 offset:8704
    ds_write_b32 v11, v129 offset:8976
    ds_write_b32 v11, v130 offset:9248
    ds_write_b32 v11, v132 offset:9792
    ds_write_b32 v11, v113 offset:13600
    ds_write_b32 v11, v114 offset:13872
    ds_write_b32 v11, v115 offset:14144
    ds_write_b32 v11, v116 offset:14416
    ds_write_b32 v11, v117 offset:14688
    ds_write_b32 v11, v118 offset:14960
    v_pk_mul_f16 v127, v123, v182 op_sel:[0,0] op_sel_hi:[1,0]
    v_pk_mul_f16 v119, v112, v111 op_sel:[0,0] op_sel_hi:[1,0]
    v_pk_mul_f16 v131, v123, v138 op_sel:[0,0] op_sel_hi:[1,0]
    v_pk_mul_f16 v133, v125, v138 op_sel:[0,0] op_sel_hi:[1,0]
    v_pk_mul_f16 v134, v126, v138 op_sel:[0,0] op_sel_hi:[1,0]
    v_pk_fma_f16 v127, v123, v182, v127 op_sel:[1,1,0] op_sel_hi:[0,1,1] neg_lo:[1,0,0]
    v_pk_fma_f16 v119, v112, v111, v119 op_sel:[1,1,0] op_sel_hi:[0,1,1] neg_lo:[1,0,0]
    v_pk_fma_f16 v131, v123, v138, v131 op_sel:[1,1,0] op_sel_hi:[0,1,1] neg_lo:[1,0,0]
    v_pk_fma_f16 v133, v125, v138, v133 op_sel:[1,1,0] op_sel_hi:[0,1,1] neg_lo:[1,0,0]
    v_pk_fma_f16 v134, v126, v138, v134 op_sel:[1,1,0] op_sel_hi:[0,1,1] neg_lo:[1,0,0]
    ds_write_b32 v11, v127 offset:8160
    ds_write_b32 v11, v119 offset:15232
    ds_write_b32 v11, v131 offset:9520
    ds_write_b32 v11, v133 offset:10064
    ds_write_b32 v11, v134 offset:10336
    v_pk_mul_f16 v140, v120, v97 op_sel:[0,0] op_sel_hi:[1,0]
    v_pk_mul_f16 v141, v120, v98 op_sel:[0,0] op_sel_hi:[1,0]
    v_pk_mul_f16 v142, v120, v99 op_sel:[0,0] op_sel_hi:[1,0]
    v_pk_mul_f16 v143, v120, v100 op_sel:[0,0] op_sel_hi:[1,0]
    v_pk_mul_f16 v144, v120, v101 op_sel:[0,0] op_sel_hi:[1,0]
    v_pk_mul_f16 v145, v120, v102 op_sel:[0,0] op_sel_hi:[1,0]
    v_pk_mul_f16 v146, v120, v103 op_sel:[0,0] op_sel_hi:[1,0]
    v_pk_mul_f16 v147, v121, v97 op_sel:[0,0] op_sel_hi:[1,0]
    v_pk_mul_f16 v148, v121, v98 op_sel:[0,0] op_sel_hi:[1,0]
    v_pk_mul_f16 v149, v121, v99 op_sel:[0,0] op_sel_hi:[1,0]
    v_pk_mul_f16 v150, v121, v100 op_sel:[0,0] op_sel_hi:[1,0]
    v_pk_mul_f16 v151, v121, v101 op_sel:[0,0] op_sel_hi:[1,0]
    v_pk_mul_f16 v152, v121, v102 op_sel:[0,0] op_sel_hi:[1,0]
    v_pk_fma_f16 v140, v120, v97, v140 op_sel:[1,1,0] op_sel_hi:[0,1,1] neg_lo:[1,0,0]
    v_pk_fma_f16 v141, v120, v98, v141 op_sel:[1,1,0] op_sel_hi:[0,1,1] neg_lo:[1,0,0]
    v_pk_fma_f16 v142, v120, v99, v142 op_sel:[1,1,0] op_sel_hi:[0,1,1] neg_lo:[1,0,0]
    v_pk_fma_f16 v143, v120, v100, v143 op_sel:[1,1,0] op_sel_hi:[0,1,1] neg_lo:[1,0,0]
    v_pk_fma_f16 v144, v120, v101, v144 op_sel:[1,1,0] op_sel_hi:[0,1,1] neg_lo:[1,0,0]
    v_pk_fma_f16 v145, v120, v102, v145 op_sel:[1,1,0] op_sel_hi:[0,1,1] neg_lo:[1,0,0]
    v_pk_fma_f16 v146, v120, v103, v146 op_sel:[1,1,0] op_sel_hi:[0,1,1] neg_lo:[1,0,0]
    v_pk_fma_f16 v147, v121, v97, v147 op_sel:[1,1,0] op_sel_hi:[0,1,1] neg_lo:[1,0,0]
    v_pk_fma_f16 v148, v121, v98, v148 op_sel:[1,1,0] op_sel_hi:[0,1,1] neg_lo:[1,0,0]
    v_pk_fma_f16 v149, v121, v99, v149 op_sel:[1,1,0] op_sel_hi:[0,1,1] neg_lo:[1,0,0]
    v_pk_fma_f16 v150, v121, v100, v150 op_sel:[1,1,0] op_sel_hi:[0,1,1] neg_lo:[1,0,0]
    v_pk_fma_f16 v151, v121, v101, v151 op_sel:[1,1,0] op_sel_hi:[0,1,1] neg_lo:[1,0,0]
    v_pk_fma_f16 v152, v121, v102, v152 op_sel:[1,1,0] op_sel_hi:[0,1,1] neg_lo:[1,0,0]
    ds_write_b32 v11, v140 offset:272
    ds_write_b32 v11, v141 offset:544
    ds_write_b32 v11, v142 offset:816
    ds_write_b32 v11, v143 offset:1088
    ds_write_b32 v11, v144 offset:1360
    ds_write_b32 v11, v145 offset:1632
    ds_write_b32 v11, v146 offset:1904
    ds_write_b32 v11, v147 offset:2448
    ds_write_b32 v11, v148 offset:2720
    ds_write_b32 v11, v149 offset:2992
    ds_write_b32 v11, v150 offset:3264
    ds_write_b32 v11, v151 offset:3536
    ds_write_b32 v11, v152 offset:3808
    v_pk_mul_f16 v153, v121, v103 op_sel:[0,0] op_sel_hi:[1,0]
    v_pk_mul_f16 v154, v122, v98 op_sel:[0,0] op_sel_hi:[1,0]
    v_pk_mul_f16 v155, v122, v100 op_sel:[0,0] op_sel_hi:[1,0]
    v_pk_mul_f16 v156, v122, v102 op_sel:[0,0] op_sel_hi:[1,0]
    v_pk_mul_f16 v157, v123, v98 op_sel:[0,0] op_sel_hi:[1,0]
    v_pk_mul_f16 v158, v123, v100 op_sel:[0,0] op_sel_hi:[1,0]
    v_pk_mul_f16 v159, v123, v102 op_sel:[0,0] op_sel_hi:[1,0]
    v_pk_mul_f16 v160, v124, v100 op_sel:[0,0] op_sel_hi:[1,0]
    v_pk_mul_f16 v161, v125, v100 op_sel:[0,0] op_sel_hi:[1,0]
    v_pk_mul_f16 v162, v126, v100 op_sel:[0,0] op_sel_hi:[1,0]
    v_pk_mul_f16 v163, v127, v100 op_sel:[0,0] op_sel_hi:[1,0]
    v_pk_mul_f16 v164, v128, v138 op_sel:[0,0] op_sel_hi:[1,0]
    v_pk_mul_f16 v165, v127, v138 op_sel:[0,0] op_sel_hi:[1,0]
    v_pk_fma_f16 v153, v121, v103, v153 op_sel:[1,1,0] op_sel_hi:[0,1,1] neg_lo:[1,0,0]
    v_pk_fma_f16 v154, v122, v98, v154 op_sel:[1,1,0] op_sel_hi:[0,1,1] neg_lo:[1,0,0]
    v_pk_fma_f16 v155, v122, v100, v155 op_sel:[1,1,0] op_sel_hi:[0,1,1] neg_lo:[1,0,0]
    v_pk_fma_f16 v156, v122, v102, v156 op_sel:[1,1,0] op_sel_hi:[0,1,1] neg_lo:[1,0,0]
    v_pk_fma_f16 v157, v123, v98, v157 op_sel:[1,1,0] op_sel_hi:[0,1,1] neg_lo:[1,0,0]
    v_pk_fma_f16 v158, v123, v100, v158 op_sel:[1,1,0] op_sel_hi:[0,1,1] neg_lo:[1,0,0]
    v_pk_fma_f16 v159, v123, v102, v159 op_sel:[1,1,0] op_sel_hi:[0,1,1] neg_lo:[1,0,0]
    v_pk_fma_f16 v160, v124, v100, v160 op_sel:[1,1,0] op_sel_hi:[0,1,1] neg_lo:[1,0,0]
    v_pk_fma_f16 v161, v125, v100, v161 op_sel:[1,1,0] op_sel_hi:[0,1,1] neg_lo:[1,0,0]
    v_pk_fma_f16 v162, v126, v100, v162 op_sel:[1,1,0] op_sel_hi:[0,1,1] neg_lo:[1,0,0]
    v_pk_fma_f16 v163, v127, v100, v163 op_sel:[1,1,0] op_sel_hi:[0,1,1] neg_lo:[1,0,0]
    v_pk_fma_f16 v164, v128, v138, v164 op_sel:[1,1,0] op_sel_hi:[0,1,1] neg_lo:[1,0,0]
    v_pk_fma_f16 v165, v127, v138, v165 op_sel:[1,1,0] op_sel_hi:[0,1,1] neg_lo:[1,0,0]
    ds_write_b32 v11, v153 offset:4080
    ds_write_b32 v11, v154 offset:4624
    ds_write_b32 v11, v155 offset:4896
    ds_write_b32 v11, v156 offset:5168
    ds_write_b32 v11, v157 offset:5712
    ds_write_b32 v11, v158 offset:5984
    ds_write_b32 v11, v159 offset:6256
    ds_write_b32 v11, v160 offset:6800
    ds_write_b32 v11, v161 offset:7344
    ds_write_b32 v11, v162 offset:7888
    ds_write_b32 v11, v163 offset:8432
    ds_write_b32 v11, v164 offset:10880
    ds_write_b32 v11, v165 offset:10608
    v_mul_u32_u24 v12, 272, v25
    v_lshl_add_u32 v12, v26, 4, v12
    v_add_u32 v12, s48, v12
    ds_read_b128 v[32:35], v12 offset:11152
    ds_read_b128 v[36:39], v12 offset:0
    ds_read_b128 v[40:43], v12 offset:4352
    ds_read_b128 v[44:47], v12 offset:8704
    ds_read_b128 v[48:51], v12 offset:11216
    ds_read_b128 v[52:55], v12 offset:64
    ds_read_b128 v[56:59], v12 offset:4416
    ds_read_b128 v[60:63], v12 offset:8768
    ds_read_b128 v[64:67], v12 offset:11280
    ds_read_b128 v[68:71], v12 offset:128
    ds_read_b128 v[72:75], v12 offset:4480
    ds_read_b128 v[76:79], v12 offset:8832
    ds_read_b128 v[80:83], v12 offset:11344
    ds_read_b128 v[84:87], v12 offset:192
    ds_read_b128 v[88:91], v12 offset:4544
    s_waitcnt lgkmcnt(14)
    ds_read_b128 v[92:95], v12 offset:8896
    v_lshlrev_b32 v13, 4, v1
    v_add_u32 v15, s48, v13
    s_lshl_b32 s48, s28, 10
    v_add_u32 v13, s48, v13
    v_mov_b32 v14, 66640
    v_lshl_add_u32 v14, v25, 4, v14
    s_waitcnt lgkmcnt(14)
    v_mfma_f32_16x16x32_f16 v[160:163], v[36:39], v[32:35], 0
    s_waitcnt lgkmcnt(13)
    v_mfma_f32_16x16x32_f16 v[164:167], v[40:43], v[32:35], 0
    s_waitcnt lgkmcnt(12)
    v_mfma_f32_16x16x32_f16 v[168:171], v[44:47], v[32:35], 0
    s_waitcnt lgkmcnt(10)
    v_mfma_f32_16x16x32_f16 v[160:163], v[52:55], v[48:51], v[160:163]
    s_waitcnt lgkmcnt(9)
    v_mfma_f32_16x16x32_f16 v[164:167], v[56:59], v[48:51], v[164:167]
    s_waitcnt lgkmcnt(8)
    v_mfma_f32_16x16x32_f16 v[168:171], v[60:63], v[48:51], v[168:171]
    s_waitcnt lgkmcnt(6)
    v_mfma_f32_16x16x32_f16 v[160:163], v[68:71], v[64:67], v[160:163]
    s_waitcnt lgkmcnt(5)
    v_mfma_f32_16x16x32_f16 v[164:167], v[72:75], v[64:67], v[164:167]
    s_waitcnt lgkmcnt(4)
    v_mfma_f32_16x16x32_f16 v[168:171], v[76:79], v[64:67], v[168:171]
    s_waitcnt lgkmcnt(2)
    v_mfma_f32_16x16x32_f16 v[160:163], v[84:87], v[80:83], v[160:163]
    s_waitcnt lgkmcnt(1)
    v_mfma_f32_16x16x32_f16 v[164:167], v[88:91], v[80:83], v[164:167]
    s_waitcnt lgkmcnt(0)
    v_mfma_f32_16x16x32_f16 v[168:171], v[92:95], v[80:83], v[168:171]
    s_nop 3
    ds_write_b128 v15, v[160:163] offset:0
    s_nop 0
    ds_write_b128 v15, v[164:167] offset:1024
    s_nop 0
    ds_write_b128 v15, v[168:171] offset:2048
    s_waitcnt lgkmcnt(0)
    s_barrier
    s_cmp_eq_u32 s28, 3
    s_cbranch_scc1 K2C_SKIPM
    ds_read_b128 v[160:163], v13 offset:0
    ds_read_b128 v[164:167], v13 offset:15504
    ds_read_b128 v[168:171], v13 offset:31008
    ds_read_b128 v[172:175], v13 offset:46512
    s_waitcnt lgkmcnt(0)
    v_add_f32 v160, v160, v164
    v_add_f32 v161, v161, v165
    v_add_f32 v162, v162, v166
    v_add_f32 v163, v163, v167
    v_add_f32 v168, v168, v172
    v_add_f32 v169, v169, v173
    v_add_f32 v170, v170, v174
    v_add_f32 v171, v171, v175
    v_add_f32 v160, v160, v168
    v_add_f32 v161, v161, v169
    v_add_f32 v162, v162, v170
    v_add_f32 v163, v163, v171
    v_mul_f32 v160, 0x3d000000, v160
    v_mul_f32 v161, 0x3d000000, v161
    v_mul_f32 v162, 0x3d000000, v162
    v_mul_f32 v163, 0x3d000000, v163
    v_cvt_pk_bf16_f32 v164, v160, v161
    v_cvt_pk_bf16_f32 v165, v162, v163
    s_cmp_eq_u32 s28, 1
    s_cbranch_scc1 K2C_M1
    s_cmp_eq_u32 s28, 2
    s_cbranch_scc1 K2C_M2
    v_lshrrev_b32 v12, 1, v26
    v_lshl_add_u32 v14, v12, 8, v14
    v_and_b32 v12, 1, v26
    v_lshl_add_u32 v14, v12, 3, v14
    ds_write_b64 v14, v[164:165]
    s_branch K2C_SKIPM
K2C_M1:
    v_lshl_add_u32 v12, v26, 8, v14
    v_lshl_add_u32 v13, v26, 9, v14
    s_mov_b32 exec_hi, 0
    ds_write_b16 v12, v164 offset:512
    ds_write_b16_d16_hi v12, v164 offset:516
    ds_write_b16 v12, v165 offset:520
    ds_write_b16_d16_hi v12, v165 offset:524
    s_mov_b32 exec_hi, -1
    s_mov_b32 exec_lo, 0
    ds_write_b16 v13, v164
    ds_write_b16_d16_hi v13, v164 offset:8
    ds_write_b16 v13, v165 offset:256
    ds_write_b16_d16_hi v13, v165 offset:264
    s_mov_b64 exec, -1
    s_branch K2C_SKIPM
K2C_M2:
    v_lshl_add_u32 v12, v26, 10, v14
    s_mov_b32 exec_hi, 0
    ds_write_b16 v12, v164 offset:2048
    ds_write_b16_d16_hi v12, v164 offset:2304
    ds_write_b16 v12, v165 offset:2560
    ds_write_b16_d16_hi v12, v165 offset:2816
    s_mov_b32 exec_hi, 1
    s_mov_b32 exec_lo, 0
    ds_write_b16 v12, v164 offset:2046
    s_mov_b64 exec, -1
K2C_SKIPM:
    s_waitcnt lgkmcnt(0)
    s_barrier
K2C_LOOP:
    ds_read_u16 v40, v16
    ds_read_u16 v41, v17
    ds_read_u16 v42, v18
    ds_read_u16 v43, v19
    ds_read_u16 v44, v20
    ds_read_u16 v45, v21
    ds_read_u16 v46, v22
    ds_read_u16 v47, v23
    ds_read_u16 v48, v24
    v_lshlrev_b32 v11, 4, v0
    v_add_u32 v11, 70784, v11
    s_lshl_b32 s48, s28, 7
    v_lshl_add_u32 v12, v26, 3, v25
    v_lshlrev_b32 v12, 1, v12
    v_and_b32 v14, 1, v25
    v_xor_b32 v14, 1, v14
    v_mul_u32_u24 v14, 4162, v14
    s_add_u32 s49, s48, 70754
    v_add3_u32 v12, v12, v14, s49
    v_lshlrev_b32 v13, 4, v26
    v_lshlrev_b32 v14, 5, v25
    v_sub_u32 v13, v13, v14
    s_add_u32 s49, s48, s53
    s_add_u32 s49, s49, 480
    v_add_u32 v13, s49, v13
    s_waitcnt lgkmcnt(0)
    v_lshl_or_b32 v32, v42, 16, v41
    v_lshl_or_b32 v36, v41, 16, v40
    v_lshl_or_b32 v33, v44, 16, v43
    v_lshl_or_b32 v37, v43, 16, v42
    v_lshl_or_b32 v34, v46, 16, v45
    v_lshl_or_b32 v38, v45, 16, v44
    v_lshl_or_b32 v35, v48, 16, v47
    v_lshl_or_b32 v39, v47, 16, v46
    ds_write_b128 v11, v[32:35]
    ds_write_b128 v11, v[36:39] offset:4160
    s_waitcnt vmcnt(0) lgkmcnt(0)
    s_barrier
    s_cmp_lg_u32 s52, 0
    s_cbranch_scc1 K2C_NOKP
    v_lshlrev_b32 v11, 4, v0
    v_add_u32 v14, 66640, v11
    ds_write_b128 v14, v[206:209]
    ds_write_b128 v11, v[210:213] offset:40960
    v_mov_b32 v14, 0
    v_mov_b32 v15, 0
    v_lshlrev_b32 v11, 3, v1
    ds_write_b64 v11, v[14:15] offset:45056
K2C_NOKP:
    ds_read_b32 v32, v12 offset:0
    ds_read_b32 v33, v12 offset:4
    ds_read_b32 v34, v12 offset:8
    ds_read_b32 v35, v12 offset:12
    ds_read_b128 v[96:99], v13 offset:3584
    ds_read_b32 v36, v12 offset:512
    ds_read_b32 v37, v12 offset:516
    ds_read_b32 v38, v12 offset:520
    ds_read_b32 v39, v12 offset:524
    ds_read_b128 v[100:103], v13 offset:3072
    ds_read_b32 v40, v12 offset:1024
    ds_read_b32 v41, v12 offset:1028
    ds_read_b32 v42, v12 offset:1032
    ds_read_b32 v43, v12 offset:1036
    ds_read_b128 v[104:107], v13 offset:2560
    s_waitcnt lgkmcnt(10)
    ds_read_b32 v44, v12 offset:1536
    ds_read_b32 v45, v12 offset:1540
    ds_read_b32 v46, v12 offset:1544
    ds_read_b32 v47, v12 offset:1548
    ds_read_b128 v[108:111], v13 offset:2048
    v_mfma_f32_16x16x32_bf16 v[160:163], v[32:35], v[96:99], 0
    s_waitcnt lgkmcnt(10)
    ds_read_b32 v48, v12 offset:2048
    ds_read_b32 v49, v12 offset:2052
    ds_read_b32 v50, v12 offset:2056
    ds_read_b32 v51, v12 offset:2060
    ds_read_b128 v[112:115], v13 offset:1536
    v_mfma_f32_16x16x32_bf16 v[164:167], v[36:39], v[96:99], 0
    v_mfma_f32_16x16x32_bf16 v[168:171], v[36:39], v[100:103], 0
    v_mfma_f32_16x16x32_bf16 v[164:167], v[32:35], v[100:103], v[164:167]
    s_waitcnt lgkmcnt(10)
    ds_read_b32 v52, v12 offset:2560
    ds_read_b32 v53, v12 offset:2564
    ds_read_b32 v54, v12 offset:2568
    ds_read_b32 v55, v12 offset:2572
    ds_read_b128 v[116:119], v13 offset:1024
    v_mfma_f32_16x16x32_bf16 v[168:171], v[40:43], v[96:99], v[168:171]
    v_mfma_f32_16x16x32_bf16 v[172:175], v[40:43], v[100:103], 0
    v_mfma_f32_16x16x32_bf16 v[176:179], v[40:43], v[104:107], 0
    v_mfma_f32_16x16x32_bf16 v[168:171], v[32:35], v[104:107], v[168:171]
    v_mfma_f32_16x16x32_bf16 v[172:175], v[36:39], v[104:107], v[172:175]
    s_waitcnt lgkmcnt(10)
    ds_read_b32 v56, v12 offset:3072
    ds_read_b32 v57, v12 offset:3076
    ds_read_b32 v58, v12 offset:3080
    ds_read_b32 v59, v12 offset:3084
    ds_read_b128 v[120:123], v13 offset:512
    v_mfma_f32_16x16x32_bf16 v[172:175], v[44:47], v[96:99], v[172:175]
    v_mfma_f32_16x16x32_bf16 v[176:179], v[44:47], v[100:103], v[176:179]
    v_mfma_f32_16x16x32_bf16 v[180:183], v[44:47], v[104:107], 0
    v_mfma_f32_16x16x32_bf16 v[184:187], v[44:47], v[108:111], 0
    v_mfma_f32_16x16x32_bf16 v[172:175], v[32:35], v[108:111], v[172:175]
    v_mfma_f32_16x16x32_bf16 v[176:179], v[36:39], v[108:111], v[176:179]
    v_mfma_f32_16x16x32_bf16 v[180:183], v[40:43], v[108:111], v[180:183]
    s_waitcnt lgkmcnt(10)
    ds_read_b32 v60, v12 offset:3584
    ds_read_b32 v61, v12 offset:3588
    ds_read_b32 v62, v12 offset:3592
    ds_read_b32 v63, v12 offset:3596
    ds_read_b128 v[124:127], v13 offset:0
    v_mfma_f32_16x16x32_bf16 v[176:179], v[48:51], v[96:99], v[176:179]
    v_mfma_f32_16x16x32_bf16 v[180:183], v[48:51], v[100:103], v[180:183]
    v_mfma_f32_16x16x32_bf16 v[184:187], v[48:51], v[104:107], v[184:187]
    v_mfma_f32_16x16x32_bf16 v[188:191], v[48:51], v[108:111], 0
    v_mfma_f32_16x16x32_bf16 v[176:179], v[32:35], v[112:115], v[176:179]
    v_mfma_f32_16x16x32_bf16 v[180:183], v[36:39], v[112:115], v[180:183]
    v_mfma_f32_16x16x32_bf16 v[184:187], v[40:43], v[112:115], v[184:187]
    v_mfma_f32_16x16x32_bf16 v[188:191], v[44:47], v[112:115], v[188:191]
    s_waitcnt lgkmcnt(10)
    ds_read_b32 v64, v12 offset:64
    ds_read_b32 v65, v12 offset:68
    ds_read_b32 v66, v12 offset:72
    ds_read_b32 v67, v12 offset:76
    ds_read_b128 v[128:131], v13 offset:3648
    v_mfma_f32_16x16x32_bf16 v[180:183], v[52:55], v[96:99], v[180:183]
    v_mfma_f32_16x16x32_bf16 v[184:187], v[52:55], v[100:103], v[184:187]
    v_mfma_f32_16x16x32_bf16 v[188:191], v[52:55], v[104:107], v[188:191]
    v_mfma_f32_16x16x32_bf16 v[180:183], v[32:35], v[116:119], v[180:183]
    v_mfma_f32_16x16x32_bf16 v[184:187], v[36:39], v[116:119], v[184:187]
    v_mfma_f32_16x16x32_bf16 v[188:191], v[40:43], v[116:119], v[188:191]
    s_waitcnt lgkmcnt(10)
    ds_read_b32 v68, v12 offset:576
    ds_read_b32 v69, v12 offset:580
    ds_read_b32 v70, v12 offset:584
    ds_read_b32 v71, v12 offset:588
    ds_read_b128 v[132:135], v13 offset:3136
    v_mfma_f32_16x16x32_bf16 v[184:187], v[56:59], v[96:99], v[184:187]
    v_mfma_f32_16x16x32_bf16 v[188:191], v[56:59], v[100:103], v[188:191]
    v_mfma_f32_16x16x32_bf16 v[184:187], v[32:35], v[120:123], v[184:187]
    v_mfma_f32_16x16x32_bf16 v[188:191], v[36:39], v[120:123], v[188:191]
    s_waitcnt lgkmcnt(10)
    ds_read_b32 v72, v12 offset:1088
    ds_read_b32 v73, v12 offset:1092
    ds_read_b32 v74, v12 offset:1096
    ds_read_b32 v75, v12 offset:1100
    ds_read_b128 v[136:139], v13 offset:2624
    v_mfma_f32_16x16x32_bf16 v[188:191], v[60:63], v[96:99], v[188:191]
    v_mfma_f32_16x16x32_bf16 v[188:191], v[32:35], v[124:127], v[188:191]
    s_waitcnt lgkmcnt(10)
    ds_read_b32 v76, v12 offset:1600
    ds_read_b32 v77, v12 offset:1604
    ds_read_b32 v78, v12 offset:1608
    ds_read_b32 v79, v12 offset:1612
    ds_read_b128 v[140:143], v13 offset:2112
    v_mfma_f32_16x16x32_bf16 v[160:163], v[64:67], v[128:131], v[160:163]
    s_waitcnt lgkmcnt(10)
    ds_read_b32 v80, v12 offset:2112
    ds_read_b32 v81, v12 offset:2116
    ds_read_b32 v82, v12 offset:2120
    ds_read_b32 v83, v12 offset:2124
    ds_read_b128 v[144:147], v13 offset:1600
    v_mfma_f32_16x16x32_bf16 v[164:167], v[68:71], v[128:131], v[164:167]
    v_mfma_f32_16x16x32_bf16 v[168:171], v[68:71], v[132:135], v[168:171]
    v_mfma_f32_16x16x32_bf16 v[164:167], v[64:67], v[132:135], v[164:167]
    s_waitcnt lgkmcnt(10)
    ds_read_b32 v84, v12 offset:2624
    ds_read_b32 v85, v12 offset:2628
    ds_read_b32 v86, v12 offset:2632
    ds_read_b32 v87, v12 offset:2636
    ds_read_b128 v[148:151], v13 offset:1088
    v_mfma_f32_16x16x32_bf16 v[168:171], v[72:75], v[128:131], v[168:171]
    v_mfma_f32_16x16x32_bf16 v[172:175], v[72:75], v[132:135], v[172:175]
    v_mfma_f32_16x16x32_bf16 v[176:179], v[72:75], v[136:139], v[176:179]
    v_mfma_f32_16x16x32_bf16 v[168:171], v[64:67], v[136:139], v[168:171]
    v_mfma_f32_16x16x32_bf16 v[172:175], v[68:71], v[136:139], v[172:175]
    s_waitcnt lgkmcnt(10)
    ds_read_b32 v88, v12 offset:3136
    ds_read_b32 v89, v12 offset:3140
    ds_read_b32 v90, v12 offset:3144
    ds_read_b32 v91, v12 offset:3148
    ds_read_b128 v[152:155], v13 offset:576
    v_mfma_f32_16x16x32_bf16 v[172:175], v[76:79], v[128:131], v[172:175]
    v_mfma_f32_16x16x32_bf16 v[176:179], v[76:79], v[132:135], v[176:179]
    v_mfma_f32_16x16x32_bf16 v[180:183], v[76:79], v[136:139], v[180:183]
    v_mfma_f32_16x16x32_bf16 v[184:187], v[76:79], v[140:143], v[184:187]
    v_mfma_f32_16x16x32_bf16 v[172:175], v[64:67], v[140:143], v[172:175]
    v_mfma_f32_16x16x32_bf16 v[176:179], v[68:71], v[140:143], v[176:179]
    v_mfma_f32_16x16x32_bf16 v[180:183], v[72:75], v[140:143], v[180:183]
    s_waitcnt lgkmcnt(10)
    ds_read_b32 v92, v12 offset:3648
    ds_read_b32 v93, v12 offset:3652
    ds_read_b32 v94, v12 offset:3656
    ds_read_b32 v95, v12 offset:3660
    ds_read_b128 v[156:159], v13 offset:64
    v_mfma_f32_16x16x32_bf16 v[176:179], v[80:83], v[128:131], v[176:179]
    v_mfma_f32_16x16x32_bf16 v[180:183], v[80:83], v[132:135], v[180:183]
    v_mfma_f32_16x16x32_bf16 v[184:187], v[80:83], v[136:139], v[184:187]
    v_mfma_f32_16x16x32_bf16 v[188:191], v[80:83], v[140:143], v[188:191]
    v_mfma_f32_16x16x32_bf16 v[176:179], v[64:67], v[144:147], v[176:179]
    v_mfma_f32_16x16x32_bf16 v[180:183], v[68:71], v[144:147], v[180:183]
    v_mfma_f32_16x16x32_bf16 v[184:187], v[72:75], v[144:147], v[184:187]
    v_mfma_f32_16x16x32_bf16 v[188:191], v[76:79], v[144:147], v[188:191]
    s_waitcnt lgkmcnt(10)
    v_mfma_f32_16x16x32_bf16 v[180:183], v[84:87], v[128:131], v[180:183]
    v_mfma_f32_16x16x32_bf16 v[184:187], v[84:87], v[132:135], v[184:187]
    v_mfma_f32_16x16x32_bf16 v[188:191], v[84:87], v[136:139], v[188:191]
    v_mfma_f32_16x16x32_bf16 v[180:183], v[64:67], v[148:151], v[180:183]
    v_mfma_f32_16x16x32_bf16 v[184:187], v[68:71], v[148:151], v[184:187]
    v_mfma_f32_16x16x32_bf16 v[188:191], v[72:75], v[148:151], v[188:191]
    s_waitcnt lgkmcnt(5)
    v_mfma_f32_16x16x32_bf16 v[184:187], v[88:91], v[128:131], v[184:187]
    v_mfma_f32_16x16x32_bf16 v[188:191], v[88:91], v[132:135], v[188:191]
    v_mfma_f32_16x16x32_bf16 v[184:187], v[64:67], v[152:155], v[184:187]
    v_mfma_f32_16x16x32_bf16 v[188:191], v[68:71], v[152:155], v[188:191]
    s_waitcnt lgkmcnt(0)
    v_mfma_f32_16x16x32_bf16 v[188:191], v[92:95], v[128:131], v[188:191]
    v_mfma_f32_16x16x32_bf16 v[188:191], v[64:67], v[156:159], v[188:191]
    s_lshl_b32 s48, s28, 13
    v_add_u32 v11, s48, v4
    ds_write_b128 v11, v[160:163] offset:0
    ds_write_b128 v11, v[164:167] offset:1024
    ds_write_b128 v11, v[168:171] offset:2048
    ds_write_b128 v11, v[172:175] offset:3072
    ds_write_b128 v11, v[176:179] offset:4096
    ds_write_b128 v11, v[180:183] offset:5120
    ds_write_b128 v11, v[184:187] offset:6144
    ds_write_b128 v11, v[188:191] offset:7168
    s_lshl_b32 s48, s28, 11
    v_add_u32 v11, s48, v4
    v_lshlrev_b32 v12, 3, v26
    v_lshl_add_u32 v12, v25, 5, v12
    s_lshl_b32 s48, s28, 10
    s_sub_u32 s49, s53, s48
    s_add_u32 s49, s49, 3576
    v_sub_u32 v13, s49, v12
    s_lshl_b32 s49, s29, 12
    s_add_u32 s49, s49, s48
    s_add_u32 s49, s49, 14680064
    s_waitcnt lgkmcnt(0)
    s_barrier
    ds_read_b128 v[32:35], v11 offset:0
    ds_read_b128 v[36:39], v11 offset:8192
    ds_read_b128 v[40:43], v11 offset:16384
    ds_read_b128 v[44:47], v11 offset:24576
    ds_read_b64 v[64:65], v13 offset:512
    ds_read_b128 v[48:51], v11 offset:1024
    ds_read_b128 v[52:55], v11 offset:9216
    ds_read_b128 v[56:59], v11 offset:17408
    ds_read_b128 v[60:63], v11 offset:25600
    ds_read_b64 v[66:67], v13 offset:0
    s_waitcnt lgkmcnt(5)
    v_pk_add_f32 v[32:33], v[32:33], v[36:37]
    v_pk_add_f32 v[40:41], v[40:41], v[44:45]
    v_pk_add_f32 v[34:35], v[34:35], v[38:39]
    v_pk_add_f32 v[42:43], v[42:43], v[46:47]
    v_pk_add_f32 v[32:33], v[32:33], v[40:41]
    v_pk_add_f32 v[34:35], v[34:35], v[42:43]
    v_and_b32 v72, 0xffff0000, v65
    v_lshlrev_b32 v73, 16, v65
    v_and_b32 v74, 0xffff0000, v64
    v_lshlrev_b32 v75, 16, v64
    v_mul_f32 v72, v72, v10
    v_mul_f32 v73, v73, v10
    v_mul_f32 v74, v74, v10
    v_mul_f32 v75, v75, v10
    v_cvt_pk_bf16_f32 v76, v32, v33
    v_cvt_pk_bf16_f32 v77, v34, v35
    v_lshlrev_b32 v32, 16, v76
    v_and_b32 v33, 0xffff0000, v76
    v_lshlrev_b32 v34, 16, v77
    v_and_b32 v35, 0xffff0000, v77
    v_cvt_pk_bf16_f32 v76, v72, v73
    v_cvt_pk_bf16_f32 v77, v74, v75
    v_lshlrev_b32 v72, 16, v76
    v_and_b32 v73, 0xffff0000, v76
    v_lshlrev_b32 v74, 16, v77
    v_and_b32 v75, 0xffff0000, v77
    v_pk_add_f32 v[32:33], v[32:33], v[72:73]
    v_pk_add_f32 v[34:35], v[34:35], v[74:75]
    v_cvt_pk_bf16_f32 v88, v32, v33
    v_cvt_pk_bf16_f32 v89, v34, v35
    s_waitcnt lgkmcnt(0)
    v_pk_add_f32 v[48:49], v[48:49], v[52:53]
    v_pk_add_f32 v[56:57], v[56:57], v[60:61]
    v_pk_add_f32 v[50:51], v[50:51], v[54:55]
    v_pk_add_f32 v[58:59], v[58:59], v[62:63]
    v_pk_add_f32 v[48:49], v[48:49], v[56:57]
    v_pk_add_f32 v[50:51], v[50:51], v[58:59]
    v_and_b32 v80, 0xffff0000, v67
    v_lshlrev_b32 v81, 16, v67
    v_and_b32 v82, 0xffff0000, v66
    v_lshlrev_b32 v83, 16, v66
    v_mul_f32 v80, v80, v10
    v_mul_f32 v81, v81, v10
    v_mul_f32 v82, v82, v10
    v_mul_f32 v83, v83, v10
    v_cvt_pk_bf16_f32 v84, v48, v49
    v_cvt_pk_bf16_f32 v85, v50, v51
    v_lshlrev_b32 v48, 16, v84
    v_and_b32 v49, 0xffff0000, v84
    v_lshlrev_b32 v50, 16, v85
    v_and_b32 v51, 0xffff0000, v85
    v_cvt_pk_bf16_f32 v84, v80, v81
    v_cvt_pk_bf16_f32 v85, v82, v83
    v_lshlrev_b32 v80, 16, v84
    v_and_b32 v81, 0xffff0000, v84
    v_lshlrev_b32 v82, 16, v85
    v_and_b32 v83, 0xffff0000, v85
    v_pk_add_f32 v[48:49], v[48:49], v[80:81]
    v_pk_add_f32 v[50:51], v[50:51], v[82:83]
    v_cvt_pk_bf16_f32 v90, v48, v49
    v_cvt_pk_bf16_f32 v91, v50, v51
    s_nop 1
    v_permlane16_swap_b32 v88, v90
    v_permlane16_swap_b32 v89, v91
    s_nop 1
    s_cmp_lg_u32 s52, 0
    s_cbranch_scc1 K2C_DONE
    s_mov_b32 s52, 1
    s_add_u32 s29, s29, 1
    s_mov_b32 s53, 40960
    v_mov_b32 v10, v205
    v_mov_b32 v214, v88
    v_mov_b32 v215, v89
    v_mov_b32 v216, v90
    v_mov_b32 v217, v91
    s_barrier
    s_branch K2C_LOOP
K2C_DONE:
    v_and_b32 v12, 1, v26
    v_lshlrev_b32 v12, 9, v12
    v_lshl_add_u32 v12, v25, 5, v12
    v_lshrrev_b32 v13, 1, v26
    v_lshl_add_u32 v12, v13, 4, v12
    buffer_store_dwordx4 v[88:91], v12, s[12:15], s49 offen sc1
    s_cmp_lg_u32 s54, 0
    s_cbranch_scc1 K2C_FIN
    s_sub_u32 s49, s49, 4096
    buffer_store_dwordx4 v[214:217], v12, s[12:15], s49 offen sc1
K2C_FIN:
    s_lshl_b32 s48, s2, 7
    s_lshl_b32 s49, s28, 2
    s_add_u32 s48, s48, s49
    s_add_u32 s48, s48, 18087936
    s_waitcnt vmcnt(0)
    v_mov_b32 v3, 0
    v_mov_b32 v4, 1
    s_mov_b64 exec, 1
    buffer_store_dword v4, v3, s[12:15], s48 offen sc1
    s_mov_b64 exec, -1
    s_endpgm
K2_END:
    s_endpgm
.section .rodata,"a"
.p2align 6
.amdhsa_kernel k1_kernel
  .amdhsa_next_free_vgpr 256
  .amdhsa_next_free_sgpr 102
  .amdhsa_accum_offset 256
  .amdhsa_group_segment_fixed_size 0
  .amdhsa_kernarg_size 120
  .amdhsa_user_sgpr_count 2
  .amdhsa_user_sgpr_kernarg_segment_ptr 1
  .amdhsa_system_sgpr_workgroup_id_x 1
.end_amdhsa_kernel
.section .rodata,"a"
.p2align 6
.amdhsa_kernel k2_kernel
  .amdhsa_next_free_vgpr 256
  .amdhsa_next_free_sgpr 102
  .amdhsa_accum_offset 256
  .amdhsa_group_segment_fixed_size 0
  .amdhsa_kernarg_size 120
  .amdhsa_user_sgpr_count 2
  .amdhsa_user_sgpr_kernarg_segment_ptr 1
  .amdhsa_system_sgpr_workgroup_id_x 1
.end_amdhsa_kernel
```
